```python
import torch

def _softmax(x, axis=-1):
    return torch.softmax(x, dim=axis)
def _gelu(x):
    return torch.nn.functional.gelu(x, approximate="tanh")
def _silu(x):
    return torch.nn.functional.silu(x)
def _sigmoid(x):
    return torch.sigmoid(x)
def _layernorm(x, axis=-1, eps=1e-5):
    m = x.mean(dim=axis, keepdim=True)
    v = x.var(dim=axis, keepdim=True, unbiased=False)
    return (x - m) / torch.sqrt(v + eps)
def _scatter_add(tgt, idx, src, axis=0):
    return tgt.clone().index_add_(axis, idx, src)
def _segment_sum(src, seg, n):
    out = torch.zeros((n,) + src.shape[1:], dtype=src.dtype)
    return out.index_add_(0, seg, src)
def _pad(x, pw):
    flat = tuple(v for pair in reversed(pw) for v in pair)
    return torch.nn.functional.pad(x, flat)

kernel_name = 'parallel_sum__ssm_conv_h3__moe_arch_mod__prompt'

def setup_inputs():

    _w = (lambda a: (lambda t: t.to(torch.bfloat16) if t.is_floating_point() else t)(torch.as_tensor(a)))
    def _A_setup():
        B, S, D = 1, 2048, 1024
        ks = 4
        return {
            "q": _w((lambda *s: torch.randn(*s, dtype=torch.bfloat16) * 0.05)(B, S, D)),
            "k": _w((lambda *s: torch.randn(*s, dtype=torch.bfloat16) * 0.8)(B, S, D)),
            "v": _w((lambda *s: torch.randn(*s, dtype=torch.bfloat16) * 0.8)(B, S, D)),
            "shift_k": _w((lambda *s: torch.randn(*s, dtype=torch.bfloat16) * 0.8)(D, ks) * 0.5),
            "ssm_k": _w((lambda *s: torch.randn(*s, dtype=torch.bfloat16) * 0.8)(D, S) * (1.0 / S ** 0.5)),
            "ssm_D": _w((lambda *s: torch.randn(*s, dtype=torch.bfloat16) * 0.8)(D)),
        }
    _A_in = _A_setup()

    def _B_setup():
        B, S, D, F, C = 1, 2048, 1024, 3584, 2
        return {
            "x": _w((lambda *s: torch.randn(*s, dtype=torch.bfloat16) * 0.05)(B, S, D)),
            "w_r": _w((lambda *s: torch.randn(*s, dtype=torch.bfloat16) * 0.05)(D)),
            "w_gate": _w((lambda *s: torch.randn(*s, dtype=torch.bfloat16) * 0.05)(D, F)),
            "w_up": _w((lambda *s: torch.randn(*s, dtype=torch.bfloat16) * 0.05)(D, F)),
            "w_down": _w((lambda *s: torch.randn(*s, dtype=torch.bfloat16) * 0.05)(F, D)),
        }
    _B_in = _B_setup()

    return {
        "A_q": _A_in["q"],
        "A_k": _A_in["k"],
        "A_v": _A_in["v"],
        "A_shift_k": _A_in["shift_k"],
        "A_ssm_k": _A_in["ssm_k"],
        "A_ssm_D": _A_in["ssm_D"],
        "B_x": _B_in["x"],
        "B_w_r": _B_in["w_r"],
        "B_w_gate": _B_in["w_gate"],
        "B_w_up": _B_in["w_up"],
        "B_w_down": _B_in["w_down"],
    }

def reference(A_q, A_k, A_v, A_shift_k, A_ssm_k, A_ssm_D, B_x, B_w_r, B_w_gate, B_w_up, B_w_down):
    def _A_ref(q, k, v, shift_k, ssm_k, ssm_D):
        B, S, D = q.shape
        ks = shift_k.shape[-1]
        k_pad = _pad(k, ((0, 0), (ks - 1, 0), (0, 0)))
        k_shift = torch.zeros_like(k)
        for t in range(ks):
            k_shift = k_shift + k_pad[:, t:t + S, :] * shift_k[:, ks - 1 - t][None, None, :]
        kv = k_shift * v
        L = 2 * S
        kv_pad = _pad(kv, ((0, 0), (0, S), (0, 0)))
        kf_pad = _pad(ssm_k, ((0, 0), (0, S)))
        kv_f = (lambda x, axes=(-2,-1): torch.fft.rfft2(x.float(), dim=axes))(kv_pad[:, None, :, :], axes=(1, 2))
        kf_f = (lambda x, axes=(-2,-1): torch.fft.rfft2(x.float(), dim=axes))(kf_pad[:, None, :], axes=(1, 2))
        kf_f = (lambda x, *d: x.permute(*d))(kf_f, 1, 2, 0)
        y_f = kv_f * kf_f[None, :, :, :]
        y = (lambda x, s, axes=(-2,-1): torch.fft.irfft2(x, s=s, dim=axes).to(torch.bfloat16))(y_f, (1, L), axes=(1, 2))[:, 0, :S, :]
        y = y + kv * ssm_D[None, None, :]
        return q * y

    def _B_ref(x, w_r, w_gate, w_up, w_down):
        B, S, D = x.shape
        C = 2
        r = x @ w_r
        idx = torch.argsort(-r, axis=-1)[:, :C]
        idx_e = (lambda x, n, axis: torch.repeat_interleave(x, n, dim=axis))(idx.reshape(B, C, 1), D, axis=2)
        x_sel = (lambda x, i, axis: torch.take_along_dim(x, i, dim=axis))(x, idx_e, axis=1)
        g = _silu(x_sel @ w_gate)
        u = x_sel @ w_up
        y = (g * u) @ w_down
        r_sel = _sigmoid((lambda x, i, axis: torch.take_along_dim(x, i, dim=axis))(r, idx, axis=1))
        y = y * r_sel.reshape(B, C, 1)
        b_off = (torch.arange(B) * S).reshape(B, 1)
        flat_idx = (idx + b_off).reshape(B * C)
        zero = (x * 0.0).reshape(B * S, D)
        upd = _scatter_add(zero, flat_idx, y.reshape(B * C, D), axis=0)
        return x + upd.reshape(B, S, D)

    x = A_q
    xn = _layernorm(x, axis=-1)
    return x + _A_ref(xn, A_k, A_v, A_shift_k, A_ssm_k, A_ssm_D) + _B_ref(xn, B_w_r, B_w_gate, B_w_up, B_w_down)
```

```asm
; @launch grid=(256,1,1) block=(256,1,1) lds=75648
.amdgcn_target "amdgcn-amd-amdhsa--gfx950"
.text
.globl parallel_sum__ssm_conv_h3__moe_arch_mod__prompt_kernel
.p2align 8
.type parallel_sum__ssm_conv_h3__moe_arch_mod__prompt_kernel,@function
parallel_sum__ssm_conv_h3__moe_arch_mod__prompt_kernel:
    s_cmp_ge_u32 s2, 256
    s_cbranch_scc1 L_end
    s_load_dwordx2 s[4:5], s[0:1], 0
    s_load_dwordx2 s[8:9], s[0:1], 8
    s_load_dwordx2 s[12:13], s[0:1], 16
    s_load_dwordx2 s[40:41], s[0:1], 24
    s_load_dwordx2 s[36:37], s[0:1], 96
    s_load_dwordx2 s[44:45], s[0:1], 56
    s_memrealtime s[98:99]
    s_getpc_b64 s[96:97]
    s_load_dwordx2 s[16:17], s[0:1], 32
    s_load_dwordx2 s[42:43], s[0:1], 40
    s_load_dwordx2 s[20:21], s[0:1], 64
    s_load_dwordx2 s[46:47], s[0:1], 72
    s_load_dwordx2 s[24:25], s[0:1], 80
    s_load_dwordx2 s[28:29], s[0:1], 88
    s_load_dwordx2 s[32:33], s[0:1], 104
    s_lshr_b32 s49, s2, 3
    s_mov_b32 s1, 0xffff0000
    s_and_b32 s100, s49, 3
    s_lshl_b32 s100, s100, 12
    v_lshl_add_u32 v22, v0, 4, s100
    global_load_dword v23, v22, s[96:97]
    s_getreg_b32 s48, hwreg(HW_REG_XCC_ID)
    s_add_u32 s48, s48, 0
    s_and_b32 s48, s48, 7
    v_lshrrev_b32 v22, 6, v0
    v_and_b32 v1, 63, v0
    v_readfirstlane_b32 s50, v22
    v_and_b32 v2, 15, v0
    v_bfe_u32 v3, v0, 4, 2
    s_mov_b32 s55, 0x200000
    s_movk_i32 s57, 4096
    s_movk_i32 s58, 8192
    s_movk_i32 s59, 12288
    s_movk_i32 s60, 16384
    s_movk_i32 s61, 20480
    s_movk_i32 s62, 24576
    s_movk_i32 s63, 28672
    s_mov_b32 s6, 4194304
    s_mov_b32 s7, 0x20000
    s_mov_b32 s10, 4194304
    s_mov_b32 s11, 0x20000
    s_mov_b32 s14, 4194304
    s_mov_b32 s15, 0x20000
    s_mov_b32 s18, 4194304
    s_mov_b32 s19, 0x20000
    s_mov_b32 s22, 7340032
    s_mov_b32 s23, 0x20000
    s_mov_b32 s26, 7340032
    s_mov_b32 s27, 0x20000
    s_mov_b32 s30, 4194304
    s_mov_b32 s31, 0x20000
    s_mov_b32 s34, 16777216
    s_mov_b32 s35, 0x20000
    s_mov_b32 s38, 256
    s_mov_b32 s39, 0x20000
    s_lshr_b32 s92, s48, 2
    s_lshl_b32 s92, s92, 6
    s_and_b32 s56, s48, 3
    s_lshl_b32 s56, s56, 2
    s_add_u32 s92, s92, s56
    s_lshl_b32 s88, 1, s49
    s_mov_b32 s90, 0
    s_lshl_b32 s53, s48, 9
    v_lshlrev_b32 v8, 4, v1
L_restart:
    s_lshl_b32 s101, s48, 10
    v_add_u32 v6, s101, v8
    s_lshl_b32 s54, s49, 2
    s_add_u32 s54, s54, s50
    s_lshl_b32 s93, s54, 15
    s_lshl_b32 s100, s48, 8
    s_add_u32 s93, s93, s100
    v_lshl_add_u32 v4, v1, 2, s93
    v_add_u32 v9, 0xffffe800, v4
    v_mov_b32 v7, 128
    s_lshl_b32 s101, s48, 7
    s_add_u32 s89, s101, s54
    s_mov_b32 s0, s89
    s_lshl_b32 s94, s0, 12
    s_waitcnt lgkmcnt(0)
    s_or_b32 s101, s50, s90
    s_cbranch_scc1 L_noclaim
    s_cmp_lg_u32 s2, 0
    s_cbranch_scc1 L_nonon
    s_or_b32 s86, s98, 1
    s_mov_b32 s87, 0
    s_atomic_cmpswap s[86:87], s[36:37], 128
L_nonon:
    s_atomic_or s88, s[36:37], s92 glc
L_noclaim:
    buffer_load_dwordx4 v[96:99], v8, s[4:7], s94 offen offset:0 nt
    buffer_load_dwordx4 v[100:103], v8, s[4:7], s94 offen offset:1024 nt
    buffer_load_dwordx4 v[104:107], v8, s[4:7], s94 offen offset:2048 nt
    buffer_load_dwordx4 v[108:111], v8, s[4:7], s94 offen offset:3072 nt
    global_load_dwordx4 v[112:115], v8, s[44:45] offset:0
    global_load_dwordx4 v[116:119], v8, s[44:45] offset:1024
    buffer_load_dword v36, v9, s[8:11], 0 offen nt
    buffer_load_dword v37, v9, s[8:11], 0 offen offset:2048 nt
    buffer_load_dword v38, v9, s[8:11], s57 offen nt
    global_load_dwordx4 v[24:27], v6, s[40:41]
    buffer_load_dword v39, v4, s[8:11], 0 offen offset:0 nt
    buffer_load_dword v56, v4, s[12:15], 0 offen offset:0 nt
    buffer_load_dword v40, v4, s[8:11], 0 offen offset:2048 nt
    buffer_load_dword v57, v4, s[12:15], 0 offen offset:2048 nt
    buffer_load_dword v41, v4, s[8:11], s57 offen offset:0 nt
    buffer_load_dword v58, v4, s[12:15], s57 offen offset:0 nt
    buffer_load_dword v42, v4, s[8:11], s57 offen offset:2048 nt
    buffer_load_dword v59, v4, s[12:15], s57 offen offset:2048 nt
    buffer_load_dword v253, v7, s[36:39], 0 offen sc1
    buffer_load_dword v43, v4, s[8:11], s58 offen offset:0 nt
    buffer_load_dword v60, v4, s[12:15], s58 offen offset:0 nt
    buffer_load_dword v44, v4, s[8:11], s58 offen offset:2048 nt
    buffer_load_dword v61, v4, s[12:15], s58 offen offset:2048 nt
    s_lshr_b32 s100, s49, 1
    s_and_b32 s56, s49, 1
    s_lshl_b32 s91, s100, 2
    s_add_u32 s91, s91, s50
    s_lshl_b32 s91, s91, 1
    s_add_u32 s91, s91, s56
    s_lshl_b32 s91, s91, 12
    s_lshl_b32 s101, s48, 19
    s_add_u32 s91, s91, s101
    s_lshl_b32 s3, s56, 14
    s_lshr_b32 s101, s100, 1
    s_lshl_b32 s101, s101, 11
    s_add_u32 s3, s3, s101
    s_and_b32 s101, s100, 1
    s_lshl_b32 s101, s101, 7
    s_add_u32 s3, s3, s101
    s_lshl_b32 s101, s48, 8
    s_add_u32 s3, s3, s101
    s_lshl_b32 s100, s50, 18
    s_add_u32 s100, s100, s3
    v_lshrrev_b32 v22, 3, v1
    v_and_b32 v13, 7, v1
    v_lshlrev_b32_e64 v12, 15, v22
    v_lshl_add_u32 v12, v13, 4, v12
    v_add_u32 v12, s100, v12
    v_lshlrev_b32 v5, 11, v22
    v_bfe_u32 v13, v1, 2, 1
    v_lshl_add_u32 v5, v13, 7, v5
    v_add_u32 v5, s93, v5
    v_and_b32 v14, 3, v1
    v_mul_u32_u24 v252, 4640, v14
    v_lshl_add_u32 v252, v13, 4, v252
    v_lshlrev_b32 v22, 5, v22
    v_sub_u32 v252, v252, v22
    v_lshl_add_u32 v5, v14, 4, v5
    s_lshl_b32 s100, s50, 8
    s_sub_u32 s100, 992, s100
    v_add_u32 v252, s100, v252
    s_lshl_b32 s101, s49, 2
    v_mov_b32 v254, s101
    v_and_b32_e64 v22, 1, v3
    v_lshl_add_u32 v250, v22, 4, v2
    v_lshlrev_b32 v250, 15, v250
    v_lshrrev_b32 v13, 1, v3
    v_lshl_add_u32 v250, v13, 4, v250
    s_lshl_b32 s100, s50, 5
    s_add_u32 s100, s100, s3
    v_add_u32 v250, s100, v250
    s_lshl_b32 s100, s54, 7
    s_add_u32 s100, s100, 131072
    v_lshl_add_u32 v251, v2, 3, s100
    s_mul_i32 s100, s54, 57344
    s_lshl_b32 s101, s48, 8
    s_add_u32 s100, s100, s101
    v_mul_u32_u24 v6, 14336, v3
    v_lshl_add_u32 v6, v2, 4, v6
    v_add_u32_e64 v6, s100, v6
    v_lshl_add_u32 v21, v1, 2, s101
    v_lshlrev_b32_e64 v9, 9, v13
    v_lshl_add_u32 v9, v2, 5, v9
    v_lshl_add_u32 v9, v22, 4, v9
    s_lshl_b32 s100, s50, 10
    s_add_u32 s100, s100, 51840
    v_add_u32 v9, s100, v9
    s_mul_i32 s93, s48, 57344
    s_lshl_b32 s101, s49, 11
    s_add_u32 s93, s93, s101
    s_add_u32 s93, s93, 262144
    s_cmp_lt_u32 s49, 28
    s_cselect_b32 s93, s93, 0x40000000
    s_mov_b32 s95, 0
    s_cmp_lg_u32 s90, 0
    s_cbranch_scc1 L_noinit
    s_cmp_lt_u32 s48, 4
    s_cselect_b64 s[20:21], s[20:21], s[46:47]
    v_and_b32 v22, 1, v2
    v_cmp_eq_u32 vcc, 1, v22
    v_mov_b32 v13, 0xffff
    v_mov_b32 v14, s1
    v_cndmask_b32 v13, v13, v14, vcc
    v_bfe_u32 v22, v2, 1, 2
    v_cmp_eq_u32 vcc, 0, v22
    s_nop 1
    v_cndmask_b32 v16, 0, v13, vcc
    v_cmp_eq_u32 vcc, 1, v22
    s_nop 1
    v_cndmask_b32 v17, 0, v13, vcc
    v_cmp_eq_u32 vcc, 2, v22
    s_nop 1
    v_cndmask_b32 v18, 0, v13, vcc
    v_cmp_eq_u32 vcc, 3, v22
    s_nop 1
    v_cndmask_b32 v19, 0, v13, vcc
    s_mul_i32 s100, s50, 4640
    s_add_u32 s101, s100, 4096
    v_lshl_add_u32 v22, v1, 3, s101
    v_mov_b32 v14, 0
    v_mov_b32_e64 v15, 0
    ds_write_b64 v22, v[14:15]
    v_mov_b32 v22, 56960
    v_mov_b32_e64 v13, s49
    ds_write_b32 v22, v13
L_noinit:
    v_and_b32 v11, 31, v1
    v_lshlrev_b32 v11, 2, v11
    v_mul_u32_u24 v15, 114688, v3
    v_lshl_add_u32 v15, v2, 4, v15
    s_mul_i32 s100, s50, 4640
    s_add_u32 s100, s100, 480
    v_lshlrev_b32 v14, 5, v2
    v_sub_u32 v14, s100, v14
    v_lshl_add_u32 v14, v3, 4, v14
    s_waitcnt vmcnt(19)
    buffer_load_dword v45, v4, s[8:11], s59 offen offset:0 nt
    v_mov_b32 v153, 0x3f803f80
    v_dot2_f32_bf16 v148, v96, v153, 0
    v_dot2_f32_bf16 v149, v104, v153, 0
    v_dot2_f32_bf16 v148, v97, v153, v148
    v_dot2_f32_bf16 v149, v105, v153, v149
    buffer_load_dword v62, v4, s[12:15], s59 offen offset:0 nt
    v_dot2_f32_bf16 v148, v98, v153, v148
    v_dot2_f32_bf16 v149, v106, v153, v149
    v_dot2_f32_bf16 v148, v99, v153, v148
    v_dot2_f32_bf16 v149, v107, v153, v149
    v_dot2_f32_bf16 v148, v100, v153, v148
    buffer_load_dword v46, v4, s[8:11], s59 offen offset:2048 nt
    v_dot2_f32_bf16 v149, v108, v153, v149
    v_dot2_f32_bf16 v148, v101, v153, v148
    v_dot2_f32_bf16 v149, v109, v153, v149
    v_dot2_f32_bf16 v148, v102, v153, v148
    v_dot2_f32_bf16 v149, v110, v153, v149
    buffer_load_dword v63, v4, s[12:15], s59 offen offset:2048 nt
    v_dot2_f32_bf16 v148, v103, v153, v148
    v_dot2_f32_bf16 v149, v111, v153, v149
    v_lshlrev_b32 v208, 16, v96
    v_and_b32 v209, s1, v96
    v_lshlrev_b32 v224, 16, v104
    buffer_load_dword v47, v4, s[8:11], s60 offen offset:0 nt
    v_and_b32_e64 v225, s1, v104
    v_add_f32_dpp v148, v148, v148 quad_perm:[1,0,3,2] row_mask:0xf bank_mask:0xf
    v_add_f32_dpp v149, v149, v149 quad_perm:[1,0,3,2] row_mask:0xf bank_mask:0xf
    v_lshlrev_b32 v210, 16, v97
    v_and_b32 v211, s1, v97
    buffer_load_dword v64, v4, s[12:15], s60 offen offset:0 nt
    v_add_f32_dpp v148, v148, v148 quad_perm:[2,3,0,1] row_mask:0xf bank_mask:0xf
    v_add_f32_dpp v149, v149, v149 quad_perm:[2,3,0,1] row_mask:0xf bank_mask:0xf
    v_lshlrev_b32 v226, 16, v105
    v_and_b32 v227, s1, v105
    v_add_f32_dpp v148, v148, v148 row_half_mirror row_mask:0xf bank_mask:0xf
    buffer_load_dword v48, v4, s[8:11], s60 offen offset:2048 nt
    v_add_f32_dpp v149, v149, v149 row_half_mirror row_mask:0xf bank_mask:0xf
    v_lshlrev_b32 v212, 16, v98
    v_and_b32 v213, s1, v98
    v_add_f32_dpp v148, v148, v148 row_mirror row_mask:0xf bank_mask:0xf
    v_add_f32_dpp v149, v149, v149 row_mirror row_mask:0xf bank_mask:0xf
    buffer_load_dword v65, v4, s[12:15], s60 offen offset:2048 nt
    v_lshlrev_b32 v228, 16, v106
    v_and_b32 v229, s1, v106
    v_add_f32_dpp v148, v148, v148 row_bcast:15 row_mask:0xa bank_mask:0xf
    v_add_f32_dpp v149, v149, v149 row_bcast:15 row_mask:0xa bank_mask:0xf
    v_lshlrev_b32_e64 v214, 16, v99
    buffer_load_dword v49, v4, s[8:11], s61 offen offset:0 nt
    v_and_b32_e64 v215, s1, v99
    v_add_f32_dpp v148, v148, v148 row_bcast:31 row_mask:0xc bank_mask:0xf
    v_add_f32_dpp v149, v149, v149 row_bcast:31 row_mask:0xc bank_mask:0xf
    v_lshlrev_b32 v230, 16, v107
    v_and_b32 v231, s1, v107
    buffer_load_dword v66, v4, s[12:15], s61 offen offset:0 nt
    v_mul_f32 v148, 0x3a800000, v148
    v_mul_f32 v149, 0x3a800000, v149
    v_cvt_pk_bf16_f32 v154, v148, v148
    v_cvt_pk_bf16_f32 v155, v149, v149
    v_lshlrev_b32_e64 v156, 16, v154
    buffer_load_dword v50, v4, s[8:11], s61 offen offset:2048 nt
    v_lshlrev_b32 v157, 16, v155
    v_sub_f32 v158, v148, v156
    v_sub_f32_e64 v159, v149, v157
    v_readlane_b32 s64, v156, 63
    v_readlane_b32 s66, v157, 63
    buffer_load_dword v67, v4, s[12:15], s61 offen offset:2048 nt
    v_lshlrev_b32 v216, 16, v100
    v_and_b32 v217, s1, v100
    v_lshlrev_b32 v232, 16, v108
    v_and_b32 v233, s1, v108
    v_lshlrev_b32_e64 v218, 16, v101
    buffer_load_dword v51, v4, s[8:11], s62 offen offset:0 nt
    v_and_b32 v219, s1, v101
    v_lshlrev_b32 v234, 16, v109
    v_and_b32 v235, s1, v109
    v_lshlrev_b32 v220, 16, v102
    v_and_b32_e64 v221, s1, v102
    buffer_load_dword v68, v4, s[12:15], s62 offen offset:0 nt
    v_lshlrev_b32 v236, 16, v110
    v_and_b32 v237, s1, v110
    v_lshlrev_b32 v222, 16, v103
    v_and_b32 v223, s1, v103
    v_lshlrev_b32_e64 v238, 16, v111
    buffer_load_dword v52, v4, s[8:11], s62 offen offset:2048 nt
    v_and_b32_e64 v239, s1, v111
    v_pk_add_f32 v[208:209], v[208:209], s[64:65] op_sel_hi:[1,0] neg_lo:[0,1] neg_hi:[0,1]
    v_pk_add_f32 v[224:225], v[224:225], s[66:67] op_sel_hi:[1,0] neg_lo:[0,1] neg_hi:[0,1]
    v_pk_add_f32 v[210:211], v[210:211], s[64:65] op_sel_hi:[1,0] neg_lo:[0,1] neg_hi:[0,1]
    v_pk_add_f32 v[226:227], v[226:227], s[66:67] op_sel_hi:[1,0] neg_lo:[0,1] neg_hi:[0,1]
    buffer_load_dword v69, v4, s[12:15], s62 offen offset:2048 nt
    v_pk_add_f32 v[212:213], v[212:213], s[64:65] op_sel_hi:[1,0] neg_lo:[0,1] neg_hi:[0,1]
    v_pk_add_f32 v[228:229], v[228:229], s[66:67] op_sel_hi:[1,0] neg_lo:[0,1] neg_hi:[0,1]
    v_pk_add_f32 v[214:215], v[214:215], s[64:65] op_sel_hi:[1,0] neg_lo:[0,1] neg_hi:[0,1]
    v_pk_add_f32 v[230:231], v[230:231], s[66:67] op_sel_hi:[1,0] neg_lo:[0,1] neg_hi:[0,1]
    v_pk_add_f32 v[216:217], v[216:217], s[64:65] op_sel_hi:[1,0] neg_lo:[0,1] neg_hi:[0,1]
    buffer_load_dword v53, v4, s[8:11], s63 offen offset:0 nt
    v_pk_add_f32 v[232:233], v[232:233], s[66:67] op_sel_hi:[1,0] neg_lo:[0,1] neg_hi:[0,1]
    v_pk_add_f32 v[218:219], v[218:219], s[64:65] op_sel_hi:[1,0] neg_lo:[0,1] neg_hi:[0,1]
    v_pk_add_f32 v[234:235], v[234:235], s[66:67] op_sel_hi:[1,0] neg_lo:[0,1] neg_hi:[0,1]
    v_pk_add_f32 v[220:221], v[220:221], s[64:65] op_sel_hi:[1,0] neg_lo:[0,1] neg_hi:[0,1]
    v_pk_add_f32 v[236:237], v[236:237], s[66:67] op_sel_hi:[1,0] neg_lo:[0,1] neg_hi:[0,1]
    buffer_load_dword v70, v4, s[12:15], s63 offen offset:0 nt
    v_pk_add_f32 v[222:223], v[222:223], s[64:65] op_sel_hi:[1,0] neg_lo:[0,1] neg_hi:[0,1]
    v_pk_add_f32 v[238:239], v[238:239], s[66:67] op_sel_hi:[1,0] neg_lo:[0,1] neg_hi:[0,1]
    v_pk_mul_f32 v[160:161], v[208:209], v[208:209]
    v_pk_mul_f32 v[162:163], v[224:225], v[224:225]
    v_pk_fma_f32 v[160:161], v[210:211], v[210:211], v[160:161]
    buffer_load_dword v54, v4, s[8:11], s63 offen offset:2048 nt
    v_pk_fma_f32 v[162:163], v[226:227], v[226:227], v[162:163]
    v_pk_fma_f32 v[160:161], v[212:213], v[212:213], v[160:161]
    v_pk_fma_f32 v[162:163], v[228:229], v[228:229], v[162:163]
    v_pk_fma_f32 v[160:161], v[214:215], v[214:215], v[160:161]
    v_pk_fma_f32 v[162:163], v[230:231], v[230:231], v[162:163]
    buffer_load_dword v71, v4, s[12:15], s63 offen offset:2048 nt
    v_pk_fma_f32 v[160:161], v[216:217], v[216:217], v[160:161]
    v_pk_fma_f32 v[162:163], v[232:233], v[232:233], v[162:163]
    v_pk_fma_f32 v[160:161], v[218:219], v[218:219], v[160:161]
    v_pk_fma_f32 v[162:163], v[234:235], v[234:235], v[162:163]
    v_pk_fma_f32 v[160:161], v[220:221], v[220:221], v[160:161]
    v_pk_fma_f32 v[162:163], v[236:237], v[236:237], v[162:163]
    v_pk_fma_f32 v[160:161], v[222:223], v[222:223], v[160:161]
    v_pk_fma_f32 v[162:163], v[238:239], v[238:239], v[162:163]
    s_waitcnt vmcnt(37)
    v_dot2_f32_bf16 v150, v96, v112, 0
    v_dot2_f32_bf16 v151, v104, v112, 0
    v_dot2_f32_bf16 v152, v112, v153, 0
    v_dot2_f32_bf16 v150, v97, v113, v150
    v_dot2_f32_bf16 v151, v105, v113, v151
    v_dot2_f32_bf16 v152, v113, v153, v152
    v_dot2_f32_bf16 v150, v98, v114, v150
    v_dot2_f32_bf16 v151, v106, v114, v151
    v_dot2_f32_bf16 v152, v114, v153, v152
    v_dot2_f32_bf16 v150, v99, v115, v150
    v_dot2_f32_bf16 v151, v107, v115, v151
    v_dot2_f32_bf16 v152, v115, v153, v152
    v_dot2_f32_bf16 v150, v100, v116, v150
    v_dot2_f32_bf16 v151, v108, v116, v151
    v_dot2_f32_bf16 v152, v116, v153, v152
    v_dot2_f32_bf16 v150, v101, v117, v150
    v_dot2_f32_bf16 v151, v109, v117, v151
    v_dot2_f32_bf16 v152, v117, v153, v152
    v_dot2_f32_bf16 v150, v102, v118, v150
    v_dot2_f32_bf16 v151, v110, v118, v151
    v_dot2_f32_bf16 v152, v118, v153, v152
    v_dot2_f32_bf16 v150, v103, v119, v150
    v_dot2_f32_bf16 v151, v111, v119, v151
    v_dot2_f32_bf16 v152, v119, v153, v152
    v_add_f32 v148, v160, v161
    v_add_f32 v149, v162, v163
    s_lshl_b32 s70, s0, 3
    v_fma_f32 v150, -s64, v152, v150
    v_fma_f32 v151, -s66, v152, v151
    s_add_u32 s70, s70, 65536
    v_add_f32_dpp v148, v148, v148 quad_perm:[1,0,3,2] row_mask:0xf bank_mask:0xf
    v_add_f32_dpp v149, v149, v149 quad_perm:[1,0,3,2] row_mask:0xf bank_mask:0xf
    v_add_f32_dpp v150, v150, v150 quad_perm:[1,0,3,2] row_mask:0xf bank_mask:0xf
    v_add_f32_dpp v151, v151, v151 quad_perm:[1,0,3,2] row_mask:0xf bank_mask:0xf
    v_add_f32_dpp v148, v148, v148 quad_perm:[2,3,0,1] row_mask:0xf bank_mask:0xf
    v_add_f32_dpp v149, v149, v149 quad_perm:[2,3,0,1] row_mask:0xf bank_mask:0xf
    v_add_f32_dpp v150, v150, v150 quad_perm:[2,3,0,1] row_mask:0xf bank_mask:0xf
    v_add_f32_dpp v151, v151, v151 quad_perm:[2,3,0,1] row_mask:0xf bank_mask:0xf
    v_add_f32_dpp v148, v148, v148 row_half_mirror row_mask:0xf bank_mask:0xf
    v_add_f32_dpp v149, v149, v149 row_half_mirror row_mask:0xf bank_mask:0xf
    v_add_f32_dpp v150, v150, v150 row_half_mirror row_mask:0xf bank_mask:0xf
    v_add_f32_dpp v151, v151, v151 row_half_mirror row_mask:0xf bank_mask:0xf
    v_add_f32_dpp v148, v148, v148 row_mirror row_mask:0xf bank_mask:0xf
    v_add_f32_dpp v149, v149, v149 row_mirror row_mask:0xf bank_mask:0xf
    v_add_f32_dpp v150, v150, v150 row_mirror row_mask:0xf bank_mask:0xf
    v_add_f32_dpp v151, v151, v151 row_mirror row_mask:0xf bank_mask:0xf
    v_add_f32_dpp v148, v148, v148 row_bcast:15 row_mask:0xa bank_mask:0xf
    v_add_f32_dpp v149, v149, v149 row_bcast:15 row_mask:0xa bank_mask:0xf
    v_add_f32_dpp v150, v150, v150 row_bcast:15 row_mask:0xa bank_mask:0xf
    v_add_f32_dpp v151, v151, v151 row_bcast:15 row_mask:0xa bank_mask:0xf
    v_add_f32_dpp v148, v148, v148 row_bcast:31 row_mask:0xc bank_mask:0xf
    v_add_f32_dpp v149, v149, v149 row_bcast:31 row_mask:0xc bank_mask:0xf
    v_add_f32_dpp v150, v150, v150 row_bcast:31 row_mask:0xc bank_mask:0xf
    v_add_f32_dpp v151, v151, v151 row_bcast:31 row_mask:0xc bank_mask:0xf
    v_mul_f32 v148, 0x3a800000, v148
    v_mul_f32 v149, 0x3a800000, v149
    v_fma_f32 v148, -v158, v158, v148
    v_fma_f32 v149, -v159, v159, v149
    v_max_f32 v148, 0, v148
    v_max_f32 v149, 0, v149
    v_cvt_pk_bf16_f32 v148, v148, v148
    v_cvt_pk_bf16_f32 v149, v149, v149
    v_lshlrev_b32 v148, 16, v148
    v_lshlrev_b32 v149, 16, v149
    v_add_f32 v148, 0x3727c5ac, v148
    v_add_f32 v149, 0x3727c5ac, v149
    v_cvt_pk_bf16_f32 v148, v148, v148
    v_cvt_pk_bf16_f32 v149, v149, v149
    v_lshlrev_b32 v148, 16, v148
    v_lshlrev_b32 v149, 16, v149
    v_sqrt_f32 v148, v148
    v_sqrt_f32 v149, v149
    v_cvt_pk_bf16_f32 v148, v148, v148
    v_cvt_pk_bf16_f32 v149, v149, v149
    v_lshlrev_b32 v164, 16, v148
    v_lshlrev_b32 v165, 16, v149
    v_rcp_f32 v148, v164
    v_rcp_f32 v149, v165
    v_mul_f32 v150, v150, v148
    v_mul_f32 v151, v151, v149
    s_mov_b32 s100, 0xffff
    v_cvt_pk_bf16_f32 v150, v150, v151
    v_and_or_b32 v144, v154, s100, v164
    v_lshrrev_b32_e64 v151, 15, v150
    v_and_or_b32 v146, v155, s100, v165
    v_and_b32 v151, 0x10001, v151
    v_readlane_b32 s66, v144, 63
    v_mul_u32_u24 v151, 0x7fff, v151
    v_readlane_b32 s68, v146, 63
    v_or_b32 v151, 0x80008000, v151
    s_lshl_b32 s71, s0, 4
    v_xor_b32 v148, v150, v151
    s_add_u32 s71, s71, 131072
    v_readlane_b32 s64, v148, 63
    buffer_load_dword v255, v7, s[36:39], 0 offen sc1
    s_waitcnt vmcnt(25)
    v_readfirstlane_b32 s65, v253
    s_nop 0
    s_mov_b32 s67, s65
    s_mov_b32 s69, s65
    s_cmp_eq_u32 s65, 0
    s_cbranch_scc1 L_nopub
    s_atomic_swap_x2 s[64:65], s[32:33], s70
    s_atomic_swap_x2 s[66:67], s[32:33], s71
    s_atomic_swap_x2 s[68:69], s[32:33], s71 offset:8
L_nopub:
    v_lshlrev_b32 v28, 16, v24
    v_lshlrev_b32 v29, 16, v26
    v_and_b32 v30, s1, v24
    v_and_b32 v31, s1, v26
    v_lshlrev_b32 v32, 16, v25
    v_lshlrev_b32 v33, 16, v27
    v_and_b32 v34, s1, v25
    v_and_b32 v35, s1, v27
    v_lshlrev_b32 v168, 16, v36
    v_and_b32 v169, s1, v36
    v_lshlrev_b32 v170, 16, v37
    v_and_b32 v171, s1, v37
    v_lshlrev_b32 v172, 16, v38
    v_and_b32_e64 v173, s1, v38
    v_pk_mul_f32 v[88:89], v[168:169], v[34:35]
    v_pk_mul_f32 v[90:91], v[170:171], v[34:35]
    v_lshlrev_b32 v174, 16, v39
    v_and_b32 v175, s1, v39
    v_lshlrev_b32 v176, 16, v40
    v_and_b32 v177, s1, v40
    v_pk_fma_f32 v[88:89], v[170:171], v[32:33], v[88:89]
    v_pk_fma_f32 v[90:91], v[172:173], v[32:33], v[90:91]
    v_lshlrev_b32 v94, 16, v57
    v_and_b32 v95, s1, v57
    v_pk_fma_f32 v[88:89], v[172:173], v[30:31], v[88:89]
    v_pk_fma_f32 v[90:91], v[174:175], v[30:31], v[90:91]
    v_lshlrev_b32 v92, 16, v56
    v_and_b32 v93, s1, v56
    v_pk_fma_f32 v[88:89], v[174:175], v[28:29], v[88:89]
    v_pk_fma_f32 v[90:91], v[176:177], v[28:29], v[90:91]
    v_pk_mul_f32 v[88:89], v[88:89], v[92:93]
    v_pk_mul_f32 v[90:91], v[90:91], v[94:95]
    v_cvt_pk_bf16_f32 v79, v90, v88
    v_cvt_pk_bf16_f32 v87, v91, v89
    v_pk_mul_f32 v[88:89], v[172:173], v[34:35]
    v_pk_mul_f32 v[90:91], v[174:175], v[34:35]
    v_lshlrev_b32 v178, 16, v41
    v_and_b32 v179, s1, v41
    v_lshlrev_b32 v180, 16, v42
    v_and_b32 v181, s1, v42
    v_pk_fma_f32 v[88:89], v[174:175], v[32:33], v[88:89]
    v_pk_fma_f32 v[90:91], v[176:177], v[32:33], v[90:91]
    v_lshlrev_b32 v94, 16, v59
    v_and_b32 v95, s1, v59
    v_pk_fma_f32 v[88:89], v[176:177], v[30:31], v[88:89]
    v_pk_fma_f32 v[90:91], v[178:179], v[30:31], v[90:91]
    v_lshlrev_b32 v92, 16, v58
    v_and_b32 v93, s1, v58
    v_pk_fma_f32 v[88:89], v[178:179], v[28:29], v[88:89]
    v_pk_fma_f32 v[90:91], v[180:181], v[28:29], v[90:91]
    v_pk_mul_f32 v[88:89], v[88:89], v[92:93]
    v_pk_mul_f32 v[90:91], v[90:91], v[94:95]
    v_cvt_pk_bf16_f32 v78, v90, v88
    v_cvt_pk_bf16_f32 v86, v91, v89
    buffer_load_dwordx4 v[120:123], v8, s[16:19], s91 offen offset:0 nt
    buffer_load_dwordx4 v[124:127], v8, s[16:19], s91 offen offset:1024 nt
    buffer_load_dwordx4 v[128:131], v8, s[16:19], s91 offen offset:2048 nt
    buffer_load_dwordx4 v[132:135], v8, s[16:19], s91 offen offset:3072 nt
    s_waitcnt vmcnt(25)
    v_pk_mul_f32 v[88:89], v[176:177], v[34:35]
    v_pk_mul_f32 v[90:91], v[178:179], v[34:35]
    v_lshlrev_b32 v182, 16, v43
    v_and_b32 v183, s1, v43
    v_lshlrev_b32 v184, 16, v44
    v_and_b32_e64 v185, s1, v44
    v_pk_fma_f32 v[88:89], v[178:179], v[32:33], v[88:89]
    v_pk_fma_f32 v[90:91], v[180:181], v[32:33], v[90:91]
    v_lshlrev_b32 v94, 16, v61
    v_and_b32 v95, s1, v61
    v_pk_fma_f32 v[88:89], v[180:181], v[30:31], v[88:89]
    v_pk_fma_f32 v[90:91], v[182:183], v[30:31], v[90:91]
    v_lshlrev_b32 v92, 16, v60
    v_and_b32 v93, s1, v60
    v_pk_fma_f32 v[88:89], v[182:183], v[28:29], v[88:89]
    v_pk_fma_f32 v[90:91], v[184:185], v[28:29], v[90:91]
    v_pk_mul_f32 v[88:89], v[88:89], v[92:93]
    v_pk_mul_f32 v[90:91], v[90:91], v[94:95]
    v_cvt_pk_bf16_f32 v77, v90, v88
    v_cvt_pk_bf16_f32 v85, v91, v89
    s_waitcnt vmcnt(21)
    v_pk_mul_f32 v[88:89], v[180:181], v[34:35]
    v_pk_mul_f32 v[90:91], v[182:183], v[34:35]
    v_lshlrev_b32 v186, 16, v45
    v_and_b32 v187, s1, v45
    v_lshlrev_b32 v188, 16, v46
    v_and_b32_e64 v189, s1, v46
    v_pk_fma_f32 v[88:89], v[182:183], v[32:33], v[88:89]
    v_pk_fma_f32 v[90:91], v[184:185], v[32:33], v[90:91]
    v_lshlrev_b32 v94, 16, v63
    v_and_b32 v95, s1, v63
    v_pk_fma_f32 v[88:89], v[184:185], v[30:31], v[88:89]
    v_pk_fma_f32 v[90:91], v[186:187], v[30:31], v[90:91]
    v_lshlrev_b32 v92, 16, v62
    v_and_b32 v93, s1, v62
    v_pk_fma_f32 v[88:89], v[186:187], v[28:29], v[88:89]
    v_pk_fma_f32 v[90:91], v[188:189], v[28:29], v[90:91]
    v_pk_mul_f32 v[88:89], v[88:89], v[92:93]
    v_pk_mul_f32 v[90:91], v[90:91], v[94:95]
    v_cvt_pk_bf16_f32 v76, v90, v88
    v_cvt_pk_bf16_f32 v84, v91, v89
    buffer_store_dwordx4 v[76:79], v5, s[28:31], 0 offen offset:64
    buffer_store_dwordx4 v[84:87], v5, s[28:31], s60 offen offset:64
    s_waitcnt vmcnt(19)
    v_pk_mul_f32 v[88:89], v[184:185], v[34:35]
    v_pk_mul_f32 v[90:91], v[186:187], v[34:35]
    v_lshlrev_b32 v190, 16, v47
    v_and_b32 v191, s1, v47
    v_lshlrev_b32 v192, 16, v48
    v_and_b32_e64 v193, s1, v48
    v_pk_fma_f32 v[88:89], v[186:187], v[32:33], v[88:89]
    v_pk_fma_f32 v[90:91], v[188:189], v[32:33], v[90:91]
    v_lshlrev_b32 v94, 16, v65
    v_and_b32 v95, s1, v65
    v_pk_fma_f32 v[88:89], v[188:189], v[30:31], v[88:89]
    v_pk_fma_f32 v[90:91], v[190:191], v[30:31], v[90:91]
    v_lshlrev_b32 v92, 16, v64
    v_and_b32 v93, s1, v64
    v_pk_fma_f32 v[88:89], v[190:191], v[28:29], v[88:89]
    v_pk_fma_f32 v[90:91], v[192:193], v[28:29], v[90:91]
    v_pk_mul_f32 v[88:89], v[88:89], v[92:93]
    v_pk_mul_f32 v[90:91], v[90:91], v[94:95]
    v_cvt_pk_bf16_f32 v75, v90, v88
    v_cvt_pk_bf16_f32 v83, v91, v89
    s_waitcnt vmcnt(15)
    v_pk_mul_f32 v[88:89], v[188:189], v[34:35]
    v_pk_mul_f32 v[90:91], v[190:191], v[34:35]
    v_lshlrev_b32 v194, 16, v49
    v_and_b32 v195, s1, v49
    v_lshlrev_b32 v196, 16, v50
    v_and_b32_e64 v197, s1, v50
    v_pk_fma_f32 v[88:89], v[190:191], v[32:33], v[88:89]
    v_pk_fma_f32 v[90:91], v[192:193], v[32:33], v[90:91]
    v_lshlrev_b32 v94, 16, v67
    v_and_b32 v95, s1, v67
    v_pk_fma_f32 v[88:89], v[192:193], v[30:31], v[88:89]
    v_pk_fma_f32 v[90:91], v[194:195], v[30:31], v[90:91]
    v_lshlrev_b32 v92, 16, v66
    v_and_b32 v93, s1, v66
    v_pk_fma_f32 v[88:89], v[194:195], v[28:29], v[88:89]
    v_pk_fma_f32 v[90:91], v[196:197], v[28:29], v[90:91]
    v_pk_mul_f32 v[88:89], v[88:89], v[92:93]
    v_pk_mul_f32 v[90:91], v[90:91], v[94:95]
    v_cvt_pk_bf16_f32 v74, v90, v88
    v_cvt_pk_bf16_f32 v82, v91, v89
    s_waitcnt vmcnt(11)
    v_pk_mul_f32 v[88:89], v[192:193], v[34:35]
    v_pk_mul_f32 v[90:91], v[194:195], v[34:35]
    v_lshlrev_b32 v198, 16, v51
    v_and_b32 v199, s1, v51
    v_lshlrev_b32 v200, 16, v52
    v_and_b32_e64 v201, s1, v52
    v_pk_fma_f32 v[88:89], v[194:195], v[32:33], v[88:89]
    v_pk_fma_f32 v[90:91], v[196:197], v[32:33], v[90:91]
    v_lshlrev_b32 v94, 16, v69
    v_and_b32 v95, s1, v69
    v_pk_fma_f32 v[88:89], v[196:197], v[30:31], v[88:89]
    v_pk_fma_f32 v[90:91], v[198:199], v[30:31], v[90:91]
    v_lshlrev_b32 v92, 16, v68
    v_and_b32 v93, s1, v68
    v_pk_fma_f32 v[88:89], v[198:199], v[28:29], v[88:89]
    v_pk_fma_f32 v[90:91], v[200:201], v[28:29], v[90:91]
    v_pk_mul_f32 v[88:89], v[88:89], v[92:93]
    v_pk_mul_f32 v[90:91], v[90:91], v[94:95]
    v_cvt_pk_bf16_f32 v73, v90, v88
    v_cvt_pk_bf16_f32 v81, v91, v89
    s_waitcnt vmcnt(7)
    v_pk_mul_f32 v[88:89], v[196:197], v[34:35]
    v_pk_mul_f32 v[90:91], v[198:199], v[34:35]
    v_lshlrev_b32 v202, 16, v53
    v_and_b32 v203, s1, v53
    v_lshlrev_b32 v204, 16, v54
    v_and_b32_e64 v205, s1, v54
    v_pk_fma_f32 v[88:89], v[198:199], v[32:33], v[88:89]
    v_pk_fma_f32 v[90:91], v[200:201], v[32:33], v[90:91]
    v_lshlrev_b32 v94, 16, v71
    v_and_b32 v95, s1, v71
    v_pk_fma_f32 v[88:89], v[200:201], v[30:31], v[88:89]
    v_pk_fma_f32 v[90:91], v[202:203], v[30:31], v[90:91]
    v_lshlrev_b32 v92, 16, v70
    v_and_b32 v93, s1, v70
    v_pk_fma_f32 v[88:89], v[202:203], v[28:29], v[88:89]
    v_pk_fma_f32 v[90:91], v[204:205], v[28:29], v[90:91]
    v_pk_mul_f32 v[88:89], v[88:89], v[92:93]
    v_pk_mul_f32 v[90:91], v[90:91], v[94:95]
    v_cvt_pk_bf16_f32 v72, v90, v88
    v_cvt_pk_bf16_f32 v80, v91, v89
    buffer_store_dwordx4 v[72:75], v5, s[28:31], 0 offen offset:0
    buffer_store_dwordx4 v[80:83], v5, s[28:31], s60 offen offset:0
    s_waitcnt vmcnt(8)
L_nonce_chk:
    v_cmp_eq_u32 vcc, 0, v255
    s_nop 0
    s_cmp_lg_u64 vcc, 0
    s_cbranch_scc1 L_nonce_re
    v_readfirstlane_b32 s51, v255
    s_cmp_lg_u32 s65, 0
    s_cbranch_scc1 L_pubd
    s_mov_b32 s65, s51
    s_mov_b32 s67, s51
    s_mov_b32 s69, s51
    s_atomic_swap_x2 s[64:65], s[32:33], s70
    s_atomic_swap_x2 s[66:67], s[32:33], s71
    s_atomic_swap_x2 s[68:69], s[32:33], s71 offset:8
L_pubd:
    s_mul_i32 s52, s51, 0x9e3779b1
    v_lshlrev_b32 v7, 4, v0
    v_add_u32 v7, 65536, v7
    v_and_b32 v22, 1, v0
    v_lshlrev_b32 v35, 9, v22
    v_lshrrev_b32_e64 v23, 1, v0
    v_lshl_add_u32 v35, v23, 2, v35
    v_add_u32 v35, 51840, v35
    v_cmp_eq_u32 vcc, 1, v22
    v_mov_b32 v23, s52
    v_lshlrev_b32 v34, 3, v0
    v_cndmask_b32 v10, v255, v23, vcc
    s_waitcnt vmcnt(0)
    s_barrier
    s_cmp_lg_u32 s50, 0
    s_cbranch_scc1 L_nf_1
    s_mov_b64 exec, 1
    buffer_store_dword v255, v254, s[32:35], s53 offen offset:0
    s_mov_b64 exec, -1
L_nf_1:
    s_and_b32 s100, s48, 3
    s_lshl_b32 s100, s100, 2
    s_add_u32 s100, s100, s50
    s_mul_i32 s94, s100, 458752
    s_lshl_b32 s101, s49, 8
    s_add_u32 s94, s94, s101
    s_cmp_lt_u32 s49, 28
    s_cselect_b32 s94, s94, 0x40000000
    s_add_u32 s72, s94, 0
    s_add_u32 s73, s94, 7168
    s_add_u32 s74, s94, 14336
    s_add_u32 s75, s94, 21504
    s_add_u32 s76, s94, 28672
    s_add_u32 s77, s94, 35840
    s_add_u32 s78, s94, 43008
    s_add_u32 s79, s94, 50176
    s_add_u32 s80, s94, 57344
    s_add_u32 s81, s94, 64512
    s_add_u32 s82, s94, 71680
    s_add_u32 s83, s94, 78848
    s_add_u32 s84, s94, 86016
    s_add_u32 s85, s94, 93184
    s_add_u32 s86, s94, 100352
    s_add_u32 s87, s94, 107520
    s_mul_i32 s100, s50, 8320
    s_add_u32 s100, s100, 18560
    v_add_u32 v13, s100, v8
    v_and_b32 v23, 1, v2
    v_xor_b32_e64 v23, 1, v23
    v_mul_u32_u24 v23, 4160, v23
    v_add_u32 v22, 1, v2
    v_lshrrev_b32 v22, 1, v22
    v_lshl_add_u32 v23, v22, 2, v23
    v_lshl_add_u32 v23, v3, 4, v23
    v_add_u32_e64 v164, s100, v23
    v_add_u32 v165, 1024, v164
    v_add_u32 v166, 2048, v164
    v_add_u32 v167, 3072, v164
    v_lshrrev_b32_e64 v22, 3, v2
    v_mul_u32_u24 v22, 4160, v22
    v_and_b32_e64 v23, 7, v2
    v_lshl_add_u32 v22, v23, 2, v22
    v_add_u32 v22, s100, v22
    v_mov_b32 v23, 0
    v_mov_b32 v160, -1
    v_mov_b32 v161, -1
    v_mov_b32 v162, -1
    v_mov_b32 v163, -1
    v_readfirstlane_b32 s101, v120
    s_nop 0
    s_lshl_b32 s101, s101, 16
    v_writelane_b32 v23, s101, 15
    s_mov_b64 exec, 0xffff
    ds_write_b32 v22, v23
    s_mov_b64 exec, -1
    v_mov_b32_dpp v136, v124 wave_rol:1 row_mask:0xf bank_mask:0xf
    v_mov_b32_dpp v137, v128 wave_rol:1 row_mask:0xf bank_mask:0xf
    v_mov_b32_dpp v138, v132 wave_rol:1 row_mask:0xf bank_mask:0xf
    v_mov_b32_dpp v136, v120 wave_shl:1 row_mask:0xf bank_mask:0xf
    v_mov_b32_dpp v137, v124 wave_shl:1 row_mask:0xf bank_mask:0xf
    v_mov_b32_dpp v138, v128 wave_shl:1 row_mask:0xf bank_mask:0xf
    v_mov_b32_dpp v139, v132 wave_shl:1 row_mask:0xf bank_mask:0xf
    ds_write_b128 v13, v[120:123] offset:32
    v_alignbit_b32 v140, v121, v120, 16
    v_alignbit_b32 v141, v122, v121, 16
    v_alignbit_b32 v142, v123, v122, 16
    v_alignbit_b32 v143, v136, v123, 16
    ds_write_b128 v13, v[140:143] offset:4192
    ds_write_b128 v13, v[124:127] offset:1056
    v_alignbit_b32 v144, v125, v124, 16
    v_alignbit_b32 v145, v126, v125, 16
    v_alignbit_b32 v146, v127, v126, 16
    v_alignbit_b32 v147, v137, v127, 16
    ds_write_b128 v13, v[144:147] offset:5216
    ds_write_b128 v13, v[128:131] offset:2080
    v_alignbit_b32 v140, v129, v128, 16
    v_alignbit_b32 v141, v130, v129, 16
    v_alignbit_b32 v142, v131, v130, 16
    v_alignbit_b32 v143, v138, v131, 16
    ds_write_b128 v13, v[140:143] offset:6240
    ds_write_b128 v13, v[132:135] offset:3104
    v_alignbit_b32 v144, v133, v132, 16
    v_alignbit_b32 v145, v134, v133, 16
    v_alignbit_b32 v146, v135, v134, 16
    v_alignbit_b32 v147, v139, v135, 16
    ds_write_b128 v13, v[144:147] offset:7264
    ds_read2_b32 a[0:1], v164 offset0:0 offset1:1
    ds_read2_b32 a[2:3], v164 offset0:2 offset1:3
    ds_read2_b32 a[32:33], v164 offset0:128 offset1:129
    ds_read2_b32 a[34:35], v164 offset0:130 offset1:131
    ds_read2_b32 a[64:65], v165 offset0:0 offset1:1
    ds_read2_b32 a[66:67], v165 offset0:2 offset1:3
    ds_read2_b32 a[96:97], v165 offset0:128 offset1:129
    ds_read2_b32 a[98:99], v165 offset0:130 offset1:131
    ds_read2_b32 a[128:129], v166 offset0:0 offset1:1
    ds_read2_b32 a[130:131], v166 offset0:2 offset1:3
    ds_read2_b32 a[160:161], v166 offset0:128 offset1:129
    ds_read2_b32 a[162:163], v166 offset0:130 offset1:131
    ds_read2_b32 a[192:193], v167 offset0:0 offset1:1
    ds_read2_b32 a[194:195], v167 offset0:2 offset1:3
    ds_read2_b32 a[224:225], v167 offset0:128 offset1:129
    ds_read2_b32 a[226:227], v167 offset0:130 offset1:131
    buffer_load_dword v253, v11, s[32:35], s53 offen sc1
    ds_read2_b32 a[4:5], v164 offset0:16 offset1:17
    ds_read2_b32 a[6:7], v164 offset0:18 offset1:19
    ds_read2_b32 a[36:37], v164 offset0:144 offset1:145
    ds_read2_b32 a[38:39], v164 offset0:146 offset1:147
    ds_read2_b32 a[68:69], v165 offset0:16 offset1:17
    ds_read2_b32 a[70:71], v165 offset0:18 offset1:19
    ds_read2_b32 a[100:101], v165 offset0:144 offset1:145
    ds_read2_b32 a[102:103], v165 offset0:146 offset1:147
    ds_read2_b32 a[132:133], v166 offset0:16 offset1:17
    ds_read2_b32 a[134:135], v166 offset0:18 offset1:19
    ds_read2_b32 a[164:165], v166 offset0:144 offset1:145
    ds_read2_b32 a[166:167], v166 offset0:146 offset1:147
    ds_read2_b32 a[196:197], v167 offset0:16 offset1:17
    ds_read2_b32 a[198:199], v167 offset0:18 offset1:19
    ds_read2_b32 a[228:229], v167 offset0:144 offset1:145
    ds_read2_b32 a[230:231], v167 offset0:146 offset1:147
L_pollw:
    s_waitcnt vmcnt(0)
    v_cmp_ne_u32 vcc, s51, v253
    s_nop 0
    s_cmp_lg_u64 vcc, 0
    s_cbranch_scc1 L_pollbad
    buffer_load_dwordx4 v[56:59], v7, s[32:35], 0 offen sc1
    buffer_load_dwordx4 v[60:63], v7, s[32:35], s57 offen sc1
    buffer_load_dwordx4 v[36:39], v12, s[28:31], 0 offen sc1
    s_mov_b32 s100, 1048576
    buffer_load_dwordx4 v[40:43], v12, s[28:31], s100 offen sc1
    s_mov_b32 s100, 2097152
    buffer_load_dwordx4 v[44:47], v12, s[28:31], s100 offen sc1
    s_mov_b32 s100, 3145728
    buffer_load_dwordx4 v[48:51], v12, s[28:31], s100 offen sc1
    ds_read2_b32 a[8:9], v164 offset0:32 offset1:33
    ds_read2_b32 a[10:11], v164 offset0:34 offset1:35
    ds_read2_b32 a[40:41], v164 offset0:160 offset1:161
    ds_read2_b32 a[42:43], v164 offset0:162 offset1:163
    ds_read2_b32 a[72:73], v165 offset0:32 offset1:33
    ds_read2_b32 a[74:75], v165 offset0:34 offset1:35
    ds_read2_b32 a[104:105], v165 offset0:160 offset1:161
    ds_read2_b32 a[106:107], v165 offset0:162 offset1:163
    ds_read2_b32 a[136:137], v166 offset0:32 offset1:33
    ds_read2_b32 a[138:139], v166 offset0:34 offset1:35
    ds_read2_b32 a[168:169], v166 offset0:160 offset1:161
    ds_read2_b32 a[170:171], v166 offset0:162 offset1:163
    ds_read2_b32 a[200:201], v167 offset0:32 offset1:33
    ds_read2_b32 a[202:203], v167 offset0:34 offset1:35
    ds_read2_b32 a[232:233], v167 offset0:160 offset1:161
    ds_read2_b32 a[234:235], v167 offset0:162 offset1:163
    s_barrier
    buffer_load_dwordx4 v[168:171], v15, s[20:23], s72 offen nt
    ds_read2_b32 a[12:13], v164 offset0:48 offset1:49
    ds_read2_b32 a[14:15], v164 offset0:50 offset1:51
    ds_read2_b32 a[44:45], v164 offset0:176 offset1:177
    ds_read2_b32 a[46:47], v164 offset0:178 offset1:179
    ds_read2_b32 a[76:77], v165 offset0:48 offset1:49
    ds_read2_b32 a[78:79], v165 offset0:50 offset1:51
    ds_read2_b32 a[108:109], v165 offset0:176 offset1:177
    ds_read2_b32 a[110:111], v165 offset0:178 offset1:179
    ds_read2_b32 a[140:141], v166 offset0:48 offset1:49
    ds_read2_b32 a[142:143], v166 offset0:50 offset1:51
    ds_read2_b32 a[172:173], v166 offset0:176 offset1:177
    ds_read2_b32 a[174:175], v166 offset0:178 offset1:179
    buffer_load_dwordx4 v[172:175], v15, s[20:23], s73 offen nt
    ds_read2_b32 a[204:205], v167 offset0:48 offset1:49
    ds_read2_b32 a[206:207], v167 offset0:50 offset1:51
    ds_read2_b32 a[236:237], v167 offset0:176 offset1:177
    ds_read2_b32 a[238:239], v167 offset0:178 offset1:179
    ds_read2_b32 a[16:17], v164 offset0:64 offset1:65
    ds_read2_b32 a[18:19], v164 offset0:66 offset1:67
    ds_read2_b32 a[48:49], v164 offset0:192 offset1:193
    ds_read2_b32 a[50:51], v164 offset0:194 offset1:195
    ds_read2_b32 a[80:81], v165 offset0:64 offset1:65
    ds_read2_b32 a[82:83], v165 offset0:66 offset1:67
    ds_read2_b32 a[112:113], v165 offset0:192 offset1:193
    ds_read2_b32 a[114:115], v165 offset0:194 offset1:195
    buffer_load_dwordx4 v[176:179], v15, s[20:23], s74 offen nt
    ds_read2_b32 a[144:145], v166 offset0:64 offset1:65
    ds_read2_b32 a[146:147], v166 offset0:66 offset1:67
    ds_read2_b32 a[176:177], v166 offset0:192 offset1:193
    ds_read2_b32 a[178:179], v166 offset0:194 offset1:195
    ds_read2_b32 a[208:209], v167 offset0:64 offset1:65
    ds_read2_b32 a[210:211], v167 offset0:66 offset1:67
    ds_read2_b32 a[240:241], v167 offset0:192 offset1:193
    ds_read2_b32 a[242:243], v167 offset0:194 offset1:195
    ds_read2_b32 a[20:21], v164 offset0:80 offset1:81
    ds_read2_b32 a[22:23], v164 offset0:82 offset1:83
    ds_read2_b32 a[52:53], v164 offset0:208 offset1:209
    ds_read2_b32 a[54:55], v164 offset0:210 offset1:211
    buffer_load_dwordx4 v[180:183], v15, s[20:23], s75 offen nt
    ds_read2_b32 a[84:85], v165 offset0:80 offset1:81
    ds_read2_b32 a[86:87], v165 offset0:82 offset1:83
    ds_read2_b32 a[116:117], v165 offset0:208 offset1:209
    ds_read2_b32 a[118:119], v165 offset0:210 offset1:211
    ds_read2_b32 a[148:149], v166 offset0:80 offset1:81
    ds_read2_b32 a[150:151], v166 offset0:82 offset1:83
    ds_read2_b32 a[180:181], v166 offset0:208 offset1:209
    ds_read2_b32 a[182:183], v166 offset0:210 offset1:211
    ds_read2_b32 a[212:213], v167 offset0:80 offset1:81
    ds_read2_b32 a[214:215], v167 offset0:82 offset1:83
    ds_read2_b32 a[244:245], v167 offset0:208 offset1:209
    ds_read2_b32 a[246:247], v167 offset0:210 offset1:211
    s_waitcnt vmcnt(8)
L_g1_chk:
    v_xor_b32 v22, s51, v57
    v_xor_b32 v23, s51, v59
    v_xor_b32 v64, s51, v61
    v_xor_b32_e64 v65, s51, v63
    v_or3_b32 v22, v22, v23, v64
    v_or_b32 v22, v22, v65
    v_cmp_ne_u32 vcc, 0, v22
    s_nop 0
    s_cmp_lg_u64 vcc, 0
    s_cbranch_scc1 L_g1_re
    s_mov_b32 s100, s1
    v_lshlrev_b32_e64 v23, 2, v0
    v_sub_u32 v23, 2047, v23
    v_lshl_or_b32 v64, v56, 16, v23
    v_subrev_u32_e64 v23, 1, v23
    v_and_or_b32 v22, v56, s100, v23
    v_subrev_u32 v23, 1, v23
    v_min_u32 v65, v64, v22
    v_max_u32_e64 v64, v64, v22
    v_lshl_or_b32 v22, v58, 16, v23
    v_subrev_u32_e64 v23, 1, v23
    v_med3_u32 v65, v64, v65, v22
    v_max_u32_e64 v64, v64, v22
    v_and_or_b32 v22, v58, s100, v23
    v_subrev_u32 v23, 1021, v23
    v_med3_u32 v65, v64, v65, v22
    v_max_u32_e64 v64, v64, v22
    v_lshl_or_b32 v22, v60, 16, v23
    v_subrev_u32_e64 v23, 1, v23
    v_med3_u32 v65, v64, v65, v22
    v_max_u32_e64 v64, v64, v22
    v_and_or_b32 v22, v60, s100, v23
    v_subrev_u32_e64 v23, 1, v23
    v_med3_u32 v65, v64, v65, v22
    v_max_u32_e64 v64, v64, v22
    v_lshl_or_b32 v22, v62, 16, v23
    v_subrev_u32_e64 v23, 1, v23
    v_med3_u32 v65, v64, v65, v22
    v_max_u32_e64 v64, v64, v22
    v_and_or_b32 v22, v62, s100, v23
    v_med3_u32 v65, v64, v65, v22
    v_max_u32 v64, v64, v22
    s_nop 1
    v_min_u32_dpp v22, v64, v64 quad_perm:[1,0,3,2] row_mask:0xf bank_mask:0xf
    v_max_u32_dpp v64, v64, v64 quad_perm:[1,0,3,2] row_mask:0xf bank_mask:0xf
    v_max_u32_dpp v65, v65, v65 quad_perm:[1,0,3,2] row_mask:0xf bank_mask:0xf
    v_max_u32_e64 v65, v65, v22
    v_min_u32_dpp v22, v64, v64 quad_perm:[2,3,0,1] row_mask:0xf bank_mask:0xf
    v_max_u32_dpp v64, v64, v64 quad_perm:[2,3,0,1] row_mask:0xf bank_mask:0xf
    v_max_u32_dpp v65, v65, v65 quad_perm:[2,3,0,1] row_mask:0xf bank_mask:0xf
    v_max_u32_e64 v65, v65, v22
    v_min_u32_dpp v22, v64, v64 row_half_mirror row_mask:0xf bank_mask:0xf
    v_max_u32_dpp v64, v64, v64 row_half_mirror row_mask:0xf bank_mask:0xf
    v_max_u32_dpp v65, v65, v65 row_half_mirror row_mask:0xf bank_mask:0xf
    v_max_u32_e64 v65, v65, v22
    v_min_u32_dpp v22, v64, v64 row_mirror row_mask:0xf bank_mask:0xf
    v_max_u32_dpp v64, v64, v64 row_mirror row_mask:0xf bank_mask:0xf
    v_max_u32_dpp v65, v65, v65 row_mirror row_mask:0xf bank_mask:0xf
    v_max_u32 v65, v65, v22
    v_lshrrev_b32 v22, 4, v0
    v_lshlrev_b32_e64 v22, 3, v22
    ds_write_b64 v22, v[64:65] offset:57024
    s_waitcnt vmcnt(7)
    ds_write_b128 v252, v[36:39] offset:3072
    s_waitcnt vmcnt(6)
    ds_write_b128 v252, v[40:43] offset:2048
    s_waitcnt vmcnt(5)
    ds_write_b128 v252, v[44:47] offset:1024
    s_waitcnt vmcnt(4)
    ds_write_b128 v252, v[48:51] offset:0
    s_waitcnt lgkmcnt(0)
    s_barrier
    ds_read_b128 v[120:123], v14 offset:3584
    ds_read_b128 v[124:127], v14 offset:3072
    ds_read_b128 v[128:131], v14 offset:2560
    ds_read_b128 v[132:135], v14 offset:2048
    ds_read_b128 v[136:139], v14 offset:1536
    ds_read_b128 v[140:143], v14 offset:1024
    ds_read_b128 v[144:147], v14 offset:512
    ds_read_b128 v[148:151], v14 offset:0
    ds_read_b128 v[152:155], v14 offset:3648
    s_waitcnt lgkmcnt(8)
    v_mfma_f32_16x16x32_bf16 v[88:91], a[0:3], v[120:123], 0
    ds_read_b128 v[156:159], v14 offset:3136
    buffer_store_dwordx4 v[160:163], v12, s[28:31], 0 offen
    v_mfma_f32_16x16x32_bf16 v[92:95], a[32:35], v[120:123], 0
    ds_read2_b32 a[24:25], v164 offset0:96 offset1:97
    s_mov_b32 s91, 1048576
    v_mfma_f32_16x16x32_bf16 v[96:99], a[64:67], v[120:123], 0
    buffer_store_dwordx4 v[160:163], v12, s[28:31], s91 offen
    v_lshlrev_b32 v23, 3, v2
    v_mfma_f32_16x16x32_bf16 v[100:103], a[96:99], v[120:123], 0
    ds_read2_b32 a[26:27], v164 offset0:98 offset1:99
    s_mov_b32 s91, 2097152
    v_mfma_f32_16x16x32_bf16 v[104:107], a[128:131], v[120:123], 0
    buffer_store_dwordx4 v[160:163], v12, s[28:31], s91 offen
    ds_read_b64 v[64:65], v23 offset:57024
    v_mfma_f32_16x16x32_bf16 v[108:111], a[160:163], v[120:123], 0
    ds_read2_b32 a[56:57], v164 offset0:224 offset1:225
    s_mov_b32 s91, 3145728
    v_mfma_f32_16x16x32_bf16 v[112:115], a[192:195], v[120:123], 0
    buffer_store_dwordx4 v[160:163], v12, s[28:31], s91 offen
    s_and_b32 s100, s48, 3
    v_mfma_f32_16x16x32_bf16 v[116:119], a[224:227], v[120:123], 0
    ds_read2_b32 a[58:59], v164 offset0:226 offset1:227
    s_waitcnt lgkmcnt(13)
    v_mfma_f32_16x16x32_bf16 v[92:95], a[0:3], v[124:127], v[92:95]
    ds_read_b128 v[120:123], v14 offset:2624
    buffer_load_dwordx4 v[184:187], v15, s[20:23], s76 offen nt
    v_mfma_f32_16x16x32_bf16 v[96:99], a[32:35], v[124:127], v[96:99]
    ds_read2_b32 a[88:89], v165 offset0:96 offset1:97
    s_lshl_b32 s100, s100, 2
    v_mfma_f32_16x16x32_bf16 v[100:103], a[64:67], v[124:127], v[100:103]
    s_add_u32 s100, s100, s50
    s_lshl_b32 s100, s100, 7
    v_mfma_f32_16x16x32_bf16 v[104:107], a[96:99], v[124:127], v[104:107]
    ds_read2_b32 a[90:91], v165 offset0:98 offset1:99
    v_cmp_lt_u32 vcc, 7, v2
    v_mfma_f32_16x16x32_bf16 v[108:111], a[128:131], v[124:127], v[108:111]
    v_mfma_f32_16x16x32_bf16 v[112:115], a[160:163], v[124:127], v[112:115]
    ds_read2_b32 a[120:121], v165 offset0:224 offset1:225
    buffer_load_dwordx4 v[188:191], v15, s[20:23], s77 offen nt
    v_mfma_f32_16x16x32_bf16 v[116:119], a[192:195], v[124:127], v[116:119]
    s_waitcnt lgkmcnt(15)
    v_mfma_f32_16x16x32_bf16 v[96:99], a[0:3], v[128:131], v[96:99]
    ds_read_b128 v[124:127], v14 offset:2112
    ds_read2_b32 a[122:123], v165 offset0:226 offset1:227
    v_mfma_f32_16x16x32_bf16 v[100:103], a[32:35], v[128:131], v[100:103]
    s_waitcnt lgkmcnt(8)
    v_mfma_f32_16x16x32_bf16 v[104:107], a[64:67], v[128:131], v[104:107]
    ds_read2_b32 a[152:153], v166 offset0:96 offset1:97
    v_min_u32_dpp v22, v64, v64 quad_perm:[1,0,3,2] row_mask:0xf bank_mask:0xf
    v_mfma_f32_16x16x32_bf16 v[108:111], a[96:99], v[128:131], v[108:111]
    v_max_u32_dpp v64, v64, v64 quad_perm:[1,0,3,2] row_mask:0xf bank_mask:0xf
    v_max_u32_dpp v65, v65, v65 quad_perm:[1,0,3,2] row_mask:0xf bank_mask:0xf
    v_mfma_f32_16x16x32_bf16 v[112:115], a[128:131], v[128:131], v[112:115]
    ds_read2_b32 a[154:155], v166 offset0:98 offset1:99
    v_max_u32_e64 v65, v65, v22
    v_mfma_f32_16x16x32_bf16 v[116:119], a[160:163], v[128:131], v[116:119]
    v_min_u32_dpp v22, v64, v64 quad_perm:[2,3,0,1] row_mask:0xf bank_mask:0xf
    v_mfma_f32_16x16x32_bf16 v[100:103], a[0:3], v[132:135], v[100:103]
    ds_read_b128 v[128:131], v14 offset:1600
    ds_read2_b32 a[184:185], v166 offset0:224 offset1:225
    v_mfma_f32_16x16x32_bf16 v[104:107], a[32:35], v[132:135], v[104:107]
    v_max_u32_dpp v64, v64, v64 quad_perm:[2,3,0,1] row_mask:0xf bank_mask:0xf
    v_max_u32_dpp v65, v65, v65 quad_perm:[2,3,0,1] row_mask:0xf bank_mask:0xf
    v_mfma_f32_16x16x32_bf16 v[108:111], a[64:67], v[132:135], v[108:111]
    ds_read2_b32 a[186:187], v166 offset0:226 offset1:227
    buffer_load_dwordx4 v[192:195], v15, s[20:23], s78 offen nt
    v_mfma_f32_16x16x32_bf16 v[112:115], a[96:99], v[132:135], v[112:115]
    v_max_u32_e64 v65, v65, v22
    v_min_u32_dpp v22, v64, v64 row_half_mirror row_mask:0xf bank_mask:0xf
    v_mfma_f32_16x16x32_bf16 v[116:119], a[128:131], v[132:135], v[116:119]
    ds_read2_b32 a[216:217], v167 offset0:96 offset1:97
    v_mfma_f32_16x16x32_bf16 v[104:107], a[0:3], v[136:139], v[104:107]
    ds_read_b128 v[132:135], v14 offset:1088
    v_max_u32_dpp v64, v64, v64 row_half_mirror row_mask:0xf bank_mask:0xf
    v_mfma_f32_16x16x32_bf16 v[108:111], a[32:35], v[136:139], v[108:111]
    ds_read2_b32 a[218:219], v167 offset0:98 offset1:99
    v_max_u32_dpp v65, v65, v65 row_half_mirror row_mask:0xf bank_mask:0xf
    v_mfma_f32_16x16x32_bf16 v[112:115], a[64:67], v[136:139], v[112:115]
    v_max_u32_e64 v65, v65, v22
    v_min_u32_dpp v22, v64, v64 row_mirror row_mask:0xf bank_mask:0xf
    v_mfma_f32_16x16x32_bf16 v[116:119], a[96:99], v[136:139], v[116:119]
    ds_read2_b32 a[248:249], v167 offset0:224 offset1:225
    v_mfma_f32_16x16x32_bf16 v[108:111], a[0:3], v[140:143], v[108:111]
    ds_read_b128 v[136:139], v14 offset:576
    v_max_u32_dpp v64, v64, v64 row_mirror row_mask:0xf bank_mask:0xf
    v_mfma_f32_16x16x32_bf16 v[112:115], a[32:35], v[140:143], v[112:115]
    ds_read2_b32 a[250:251], v167 offset0:226 offset1:227
    v_max_u32_dpp v65, v65, v65 row_mirror row_mask:0xf bank_mask:0xf
    v_mfma_f32_16x16x32_bf16 v[116:119], a[64:67], v[140:143], v[116:119]
    v_max_u32_e64 v65, v65, v22
    v_mfma_f32_16x16x32_bf16 v[112:115], a[0:3], v[144:147], v[112:115]
    ds_read_b128 v[140:143], v14 offset:64
    ds_read2_b32 a[28:29], v164 offset0:112 offset1:113
    v_mfma_f32_16x16x32_bf16 v[116:119], a[32:35], v[144:147], v[116:119]
    buffer_load_dwordx4 v[196:199], v15, s[20:23], s79 offen nt
    v_mfma_f32_16x16x32_bf16 v[116:119], a[0:3], v[148:151], v[116:119]
    ds_read_b128 v[144:147], v14 offset:3712
    ds_read2_b32 a[30:31], v164 offset0:114 offset1:115
    v_mfma_f32_16x16x32_bf16 v[88:91], a[4:7], v[152:155], v[88:91]
    ds_read_b128 v[148:151], v14 offset:3200
    v_cndmask_b32 v22, v64, v65, vcc
    v_mfma_f32_16x16x32_bf16 v[92:95], a[36:39], v[152:155], v[92:95]
    ds_read2_b32 a[60:61], v164 offset0:240 offset1:241
    v_not_b32 v22, v22
    v_mfma_f32_16x16x32_bf16 v[96:99], a[68:71], v[152:155], v[96:99]
    v_and_b32 v22, 0x7ff, v22
    v_lshlrev_b32_e64 v13, 3, v22
    v_mfma_f32_16x16x32_bf16 v[100:103], a[100:103], v[152:155], v[100:103]
    ds_read2_b32 a[62:63], v164 offset0:242 offset1:243
    v_lshlrev_b32_e64 v22, 11, v22
    v_mfma_f32_16x16x32_bf16 v[104:107], a[132:135], v[152:155], v[104:107]
    v_lshl_add_u32 v22, v3, 5, v22
    buffer_load_dwordx4 v[24:27], v22, s[4:7], s100 offen
    v_mfma_f32_16x16x32_bf16 v[108:111], a[164:167], v[152:155], v[108:111]
    ds_read2_b32 a[92:93], v165 offset0:112 offset1:113
    buffer_load_dwordx4 v[28:31], v22, s[4:7], s100 offen offset:16
    v_mfma_f32_16x16x32_bf16 v[112:115], a[196:199], v[152:155], v[112:115]
    v_add_u32 v13, 131072, v13
    buffer_load_dwordx2 v[32:33], v13, s[32:35], 0 offen sc1
    v_mfma_f32_16x16x32_bf16 v[116:119], a[228:231], v[152:155], v[116:119]
    ds_read2_b32 a[94:95], v165 offset0:114 offset1:115
    v_mfma_f32_16x16x32_bf16 v[92:95], a[4:7], v[156:159], v[92:95]
    ds_read_b128 v[152:155], v14 offset:2688
    buffer_load_dwordx4 v[200:203], v15, s[20:23], s80 offen nt
    v_mfma_f32_16x16x32_bf16 v[96:99], a[36:39], v[156:159], v[96:99]
    ds_read2_b32 a[124:125], v165 offset0:240 offset1:241
    v_readfirstlane_b32 s98, v64
    v_mfma_f32_16x16x32_bf16 v[100:103], a[68:71], v[156:159], v[100:103]
    v_readfirstlane_b32 s99, v65
    v_and_b32_e64 v22, 1, v3
    v_mfma_f32_16x16x32_bf16 v[104:107], a[100:103], v[156:159], v[104:107]
    ds_read2_b32 a[126:127], v165 offset0:242 offset1:243
    v_lshl_add_u32 v250, v22, 4, v2
    v_mfma_f32_16x16x32_bf16 v[108:111], a[132:135], v[156:159], v[108:111]
    v_mul_u32_u24 v250, 144, v250
    v_lshrrev_b32_e64 v22, 1, v3
    v_mfma_f32_16x16x32_bf16 v[112:115], a[164:167], v[156:159], v[112:115]
    ds_read2_b32 a[156:157], v166 offset0:112 offset1:113
    v_lshl_add_u32 v250, v22, 4, v250
    v_mfma_f32_16x16x32_bf16 v[116:119], a[196:199], v[156:159], v[116:119]
    s_lshl_b32 s100, s50, 5
    s_waitcnt lgkmcnt(15)
    v_mfma_f32_16x16x32_bf16 v[96:99], a[4:7], v[120:123], v[96:99]
    ds_read_b128 v[156:159], v14 offset:2176
    ds_read2_b32 a[158:159], v166 offset0:114 offset1:115
    v_mfma_f32_16x16x32_bf16 v[100:103], a[36:39], v[120:123], v[100:103]
    s_add_u32 s100, s100, 57216
    v_add_u32_e64 v250, s100, v250
    v_mfma_f32_16x16x32_bf16 v[104:107], a[68:71], v[120:123], v[104:107]
    ds_read2_b32 a[188:189], v166 offset0:240 offset1:241
    buffer_load_dwordx4 v[204:207], v15, s[20:23], s81 offen nt
    v_mfma_f32_16x16x32_bf16 v[108:111], a[100:103], v[120:123], v[108:111]
    v_lshrrev_b32_e64 v252, 3, v0
    v_mul_u32_u24 v252, 144, v252
    v_mfma_f32_16x16x32_bf16 v[112:115], a[132:135], v[120:123], v[112:115]
    ds_read2_b32 a[190:191], v166 offset0:242 offset1:243
    v_and_b32_e64 v22, 7, v0
    v_mfma_f32_16x16x32_bf16 v[116:119], a[164:167], v[120:123], v[116:119]
    v_lshl_add_u32 v252, v22, 4, v252
    s_waitcnt lgkmcnt(15)
    v_mfma_f32_16x16x32_bf16 v[100:103], a[4:7], v[124:127], v[100:103]
    ds_read_b128 v[120:123], v14 offset:1664
    ds_read2_b32 a[220:221], v167 offset0:112 offset1:113
    v_mfma_f32_16x16x32_bf16 v[104:107], a[36:39], v[124:127], v[104:107]
    v_add_u32 v252, 57216, v252
    v_mfma_f32_16x16x32_bf16 v[108:111], a[68:71], v[124:127], v[108:111]
    ds_read2_b32 a[222:223], v167 offset0:114 offset1:115
    v_mfma_f32_16x16x32_bf16 v[112:115], a[100:103], v[124:127], v[112:115]
    v_mfma_f32_16x16x32_bf16 v[116:119], a[132:135], v[124:127], v[116:119]
    ds_read2_b32 a[252:253], v167 offset0:240 offset1:241
    s_waitcnt lgkmcnt(15)
    v_mfma_f32_16x16x32_bf16 v[104:107], a[4:7], v[128:131], v[104:107]
    ds_read_b128 v[124:127], v14 offset:1152
    v_mfma_f32_16x16x32_bf16 v[108:111], a[36:39], v[128:131], v[108:111]
    ds_read2_b32 a[254:255], v167 offset0:242 offset1:243
    buffer_load_dwordx4 v[208:211], v15, s[20:23], s82 offen nt
    v_mfma_f32_16x16x32_bf16 v[112:115], a[68:71], v[128:131], v[112:115]
    v_mfma_f32_16x16x32_bf16 v[116:119], a[100:103], v[128:131], v[116:119]
    s_waitcnt lgkmcnt(15)
    v_mfma_f32_16x16x32_bf16 v[108:111], a[4:7], v[132:135], v[108:111]
    ds_read_b128 v[128:131], v14 offset:640
    v_mfma_f32_16x16x32_bf16 v[112:115], a[36:39], v[132:135], v[112:115]
    v_mfma_f32_16x16x32_bf16 v[116:119], a[68:71], v[132:135], v[116:119]
    v_mfma_f32_16x16x32_bf16 v[112:115], a[4:7], v[136:139], v[112:115]
    ds_read_b128 v[132:135], v14 offset:128
    v_mfma_f32_16x16x32_bf16 v[116:119], a[36:39], v[136:139], v[116:119]
    s_waitcnt lgkmcnt(15)
    v_mfma_f32_16x16x32_bf16 v[116:119], a[4:7], v[140:143], v[116:119]
    ds_read_b128 v[136:139], v14 offset:3776
    s_waitcnt lgkmcnt(15)
    v_mfma_f32_16x16x32_bf16 v[88:91], a[8:11], v[144:147], v[88:91]
    ds_read_b128 v[140:143], v14 offset:3264
    v_mfma_f32_16x16x32_bf16 v[92:95], a[40:43], v[144:147], v[92:95]
    buffer_load_dwordx4 v[212:215], v15, s[20:23], s83 offen nt
    v_mfma_f32_16x16x32_bf16 v[96:99], a[72:75], v[144:147], v[96:99]
    v_mfma_f32_16x16x32_bf16 v[100:103], a[104:107], v[144:147], v[100:103]
    v_mfma_f32_16x16x32_bf16 v[104:107], a[136:139], v[144:147], v[104:107]
    v_mfma_f32_16x16x32_bf16 v[108:111], a[168:171], v[144:147], v[108:111]
    v_mfma_f32_16x16x32_bf16 v[112:115], a[200:203], v[144:147], v[112:115]
    v_mfma_f32_16x16x32_bf16 v[116:119], a[232:235], v[144:147], v[116:119]
    s_waitcnt lgkmcnt(15)
    v_mfma_f32_16x16x32_bf16 v[92:95], a[8:11], v[148:151], v[92:95]
    ds_read_b128 v[144:147], v14 offset:2752
    v_mfma_f32_16x16x32_bf16 v[96:99], a[40:43], v[148:151], v[96:99]
    v_mfma_f32_16x16x32_bf16 v[100:103], a[72:75], v[148:151], v[100:103]
    v_mfma_f32_16x16x32_bf16 v[104:107], a[104:107], v[148:151], v[104:107]
    buffer_load_dwordx4 v[216:219], v15, s[20:23], s84 offen nt
    v_mfma_f32_16x16x32_bf16 v[108:111], a[136:139], v[148:151], v[108:111]
    v_mfma_f32_16x16x32_bf16 v[112:115], a[168:171], v[148:151], v[112:115]
    v_mfma_f32_16x16x32_bf16 v[116:119], a[200:203], v[148:151], v[116:119]
    s_waitcnt lgkmcnt(15)
    v_mfma_f32_16x16x32_bf16 v[96:99], a[8:11], v[152:155], v[96:99]
    ds_read_b128 v[148:151], v14 offset:2240
    v_mfma_f32_16x16x32_bf16 v[100:103], a[40:43], v[152:155], v[100:103]
    v_mfma_f32_16x16x32_bf16 v[104:107], a[72:75], v[152:155], v[104:107]
    s_waitcnt vmcnt(12)
    s_barrier
    v_mfma_f32_16x16x32_bf16 v[108:111], a[104:107], v[152:155], v[108:111]
    s_cmp_lg_u32 s50, 0
    s_cbranch_scc1 L_nf_2
    s_mov_b64 exec, 1
    buffer_store_dword v255, v254, s[32:35], s53 offen offset:128
    s_mov_b64 exec, -1
L_nf_2:
    v_mfma_f32_16x16x32_bf16 v[112:115], a[136:139], v[152:155], v[112:115]
    s_waitcnt vmcnt(5)
L_xs_chk:
    v_cmp_ne_u32 vcc, s51, v33
    s_nop 0
    s_cmp_lg_u64 vcc, 0
    s_cbranch_scc1 L_xs_re
    v_mfma_f32_16x16x32_bf16 v[116:119], a[168:171], v[152:155], v[116:119]
    v_and_b32 v33, s1, v32
    s_waitcnt lgkmcnt(15)
    v_mfma_f32_16x16x32_bf16 v[100:103], a[8:11], v[156:159], v[100:103]
    ds_read_b128 v[152:155], v14 offset:1728
    buffer_load_dwordx4 v[220:223], v15, s[20:23], s85 offen nt
    v_mfma_f32_16x16x32_bf16 v[104:107], a[40:43], v[156:159], v[104:107]
    v_lshlrev_b32 v32, 16, v32
    v_rcp_f32 v33, v33
    v_mfma_f32_16x16x32_bf16 v[108:111], a[72:75], v[156:159], v[108:111]
    v_lshlrev_b32 v36, 16, v24
    v_and_b32 v37, s1, v24
    v_mfma_f32_16x16x32_bf16 v[112:115], a[104:107], v[156:159], v[112:115]
    v_lshlrev_b32 v38, 16, v25
    v_and_b32 v39, s1, v25
    v_mfma_f32_16x16x32_bf16 v[116:119], a[136:139], v[156:159], v[116:119]
    v_lshlrev_b32 v40, 16, v26
    s_waitcnt lgkmcnt(12)
    v_mfma_f32_16x16x32_bf16 v[104:107], a[8:11], v[120:123], v[104:107]
    ds_read_b128 v[156:159], v14 offset:1216
    v_and_b32_e64 v41, s1, v26
    v_mfma_f32_16x16x32_bf16 v[108:111], a[40:43], v[120:123], v[108:111]
    v_lshlrev_b32 v42, 16, v27
    v_and_b32 v43, s1, v27
    v_mfma_f32_16x16x32_bf16 v[112:115], a[72:75], v[120:123], v[112:115]
    v_lshlrev_b32 v44, 16, v28
    v_and_b32 v45, s1, v28
    v_mfma_f32_16x16x32_bf16 v[116:119], a[104:107], v[120:123], v[116:119]
    v_lshlrev_b32 v46, 16, v29
    s_waitcnt lgkmcnt(7)
    v_mfma_f32_16x16x32_bf16 v[108:111], a[8:11], v[124:127], v[108:111]
    ds_read_b128 v[120:123], v14 offset:704
    v_and_b32_e64 v47, s1, v29
    v_mfma_f32_16x16x32_bf16 v[112:115], a[40:43], v[124:127], v[112:115]
    buffer_load_dwordx4 v[224:227], v15, s[20:23], s86 offen nt
    v_lshlrev_b32_e64 v48, 16, v30
    v_mfma_f32_16x16x32_bf16 v[116:119], a[72:75], v[124:127], v[116:119]
    v_and_b32_e64 v49, s1, v30
    v_mfma_f32_16x16x32_bf16 v[112:115], a[8:11], v[128:131], v[112:115]
    ds_read_b128 v[124:127], v14 offset:192
    v_lshlrev_b32_e64 v50, 16, v31
    v_mfma_f32_16x16x32_bf16 v[116:119], a[40:43], v[128:131], v[116:119]
    v_and_b32 v51, s1, v31
    s_waitcnt lgkmcnt(8)
    v_mfma_f32_16x16x32_bf16 v[116:119], a[8:11], v[132:135], v[116:119]
    ds_read_b128 v[128:131], v14 offset:3840
    s_waitcnt lgkmcnt(8)
    v_mfma_f32_16x16x32_bf16 v[88:91], a[12:15], v[136:139], v[88:91]
    ds_read_b128 v[132:135], v14 offset:3328
    v_mul_f32 v32, v32, v33
    v_mfma_f32_16x16x32_bf16 v[92:95], a[44:47], v[136:139], v[92:95]
    v_fma_f32 v36, v36, v33, -v32
    v_fma_f32 v37, v37, v33, -v32
    v_mfma_f32_16x16x32_bf16 v[96:99], a[76:79], v[136:139], v[96:99]
    v_fma_f32 v38, v38, v33, -v32
    v_fma_f32 v39, v39, v33, -v32
    v_mfma_f32_16x16x32_bf16 v[100:103], a[108:111], v[136:139], v[100:103]
    v_fma_f32 v40, v40, v33, -v32
    v_fma_f32 v41, v41, v33, -v32
    v_mfma_f32_16x16x32_bf16 v[104:107], a[140:143], v[136:139], v[104:107]
    v_fma_f32 v42, v42, v33, -v32
    v_fma_f32 v43, v43, v33, -v32
    v_mfma_f32_16x16x32_bf16 v[108:111], a[172:175], v[136:139], v[108:111]
    buffer_load_dwordx4 v[228:231], v15, s[20:23], s87 offen nt
    v_fma_f32 v44, v44, v33, -v32
    v_mfma_f32_16x16x32_bf16 v[112:115], a[204:207], v[136:139], v[112:115]
    v_fma_f32 v45, v45, v33, -v32
    v_fma_f32 v46, v46, v33, -v32
    v_mfma_f32_16x16x32_bf16 v[116:119], a[236:239], v[136:139], v[116:119]
    v_fma_f32 v47, v47, v33, -v32
    s_waitcnt lgkmcnt(8)
    v_mfma_f32_16x16x32_bf16 v[92:95], a[12:15], v[140:143], v[92:95]
    ds_read_b128 v[136:139], v14 offset:2816
    v_fma_f32 v48, v48, v33, -v32
    v_mfma_f32_16x16x32_bf16 v[96:99], a[44:47], v[140:143], v[96:99]
    v_fma_f32 v49, v49, v33, -v32
    v_fma_f32 v50, v50, v33, -v32
    v_mfma_f32_16x16x32_bf16 v[100:103], a[76:79], v[140:143], v[100:103]
    v_fma_f32 v51, v51, v33, -v32
    v_cvt_pk_bf16_f32 v36, v36, v36
    v_mfma_f32_16x16x32_bf16 v[104:107], a[108:111], v[140:143], v[104:107]
    v_cvt_pk_bf16_f32 v37, v37, v37
    v_cvt_pk_bf16_f32 v38, v38, v38
    v_mfma_f32_16x16x32_bf16 v[108:111], a[140:143], v[140:143], v[108:111]
    v_cvt_pk_bf16_f32 v39, v39, v39
    v_cvt_pk_bf16_f32 v40, v40, v40
    v_mfma_f32_16x16x32_bf16 v[112:115], a[172:175], v[140:143], v[112:115]
    v_cvt_pk_bf16_f32 v41, v41, v41
    v_cvt_pk_bf16_f32 v42, v42, v42
    v_mfma_f32_16x16x32_bf16 v[116:119], a[204:207], v[140:143], v[116:119]
    v_cvt_pk_bf16_f32 v43, v43, v43
    s_waitcnt lgkmcnt(8)
    v_mfma_f32_16x16x32_bf16 v[96:99], a[12:15], v[144:147], v[96:99]
    ds_read_b128 v[140:143], v14 offset:2304
    buffer_load_dwordx2 v[248:249], v251, s[32:35], 0 offen sc1
    v_mfma_f32_16x16x32_bf16 v[100:103], a[44:47], v[144:147], v[100:103]
    global_load_dword v21, v21, s[42:43]
    v_cvt_pk_bf16_f32 v44, v44, v44
    v_mfma_f32_16x16x32_bf16 v[104:107], a[76:79], v[144:147], v[104:107]
    buffer_load_dword v232, v4, s[4:7], 0 offen offset:0 nt
    v_cvt_pk_bf16_f32 v45, v45, v45
    v_mfma_f32_16x16x32_bf16 v[108:111], a[108:111], v[144:147], v[108:111]
    buffer_load_dword v233, v4, s[4:7], 0 offen offset:2048 nt
    v_cvt_pk_bf16_f32 v46, v46, v46
    v_mfma_f32_16x16x32_bf16 v[112:115], a[140:143], v[144:147], v[112:115]
    buffer_load_dword v234, v4, s[4:7], s57 offen offset:0 nt
    v_cvt_pk_bf16_f32 v47, v47, v47
    v_mfma_f32_16x16x32_bf16 v[116:119], a[172:175], v[144:147], v[116:119]
    buffer_load_dword v235, v4, s[4:7], s57 offen offset:2048 nt
    s_waitcnt lgkmcnt(8)
    v_mfma_f32_16x16x32_bf16 v[100:103], a[12:15], v[148:151], v[100:103]
    ds_read_b128 v[144:147], v14 offset:1792
    v_cvt_pk_bf16_f32 v48, v48, v48
    v_mfma_f32_16x16x32_bf16 v[104:107], a[44:47], v[148:151], v[104:107]
    v_cvt_pk_bf16_f32 v49, v49, v49
    v_cvt_pk_bf16_f32 v50, v50, v50
    v_mfma_f32_16x16x32_bf16 v[108:111], a[76:79], v[148:151], v[108:111]
    v_cvt_pk_bf16_f32 v51, v51, v51
    v_and_b32 v52, v36, v16
    v_mfma_f32_16x16x32_bf16 v[112:115], a[108:111], v[148:151], v[112:115]
    v_and_b32 v53, v36, v17
    v_and_b32 v54, v36, v18
    v_mfma_f32_16x16x32_bf16 v[116:119], a[140:143], v[148:151], v[116:119]
    buffer_load_dword v236, v4, s[4:7], s58 offen offset:0 nt
    s_waitcnt lgkmcnt(8)
    v_mfma_f32_16x16x32_bf16 v[104:107], a[12:15], v[152:155], v[104:107]
    ds_read_b128 v[148:151], v14 offset:1280
    buffer_load_dword v237, v4, s[4:7], s58 offen offset:2048 nt
    v_mfma_f32_16x16x32_bf16 v[108:111], a[44:47], v[152:155], v[108:111]
    buffer_load_dword v238, v4, s[4:7], s59 offen offset:0 nt
    v_and_b32 v55, v36, v19
    v_mfma_f32_16x16x32_bf16 v[112:115], a[76:79], v[152:155], v[112:115]
    buffer_load_dword v239, v4, s[4:7], s59 offen offset:2048 nt
    v_and_b32_e64 v56, v37, v16
    v_mfma_f32_16x16x32_bf16 v[116:119], a[108:111], v[152:155], v[116:119]
    v_and_b32 v57, v37, v17
    s_waitcnt lgkmcnt(7)
    v_mfma_f32_16x16x32_bf16 v[108:111], a[12:15], v[156:159], v[108:111]
    ds_read_b128 v[152:155], v14 offset:768
    v_and_b32_e64 v58, v37, v18
    v_mfma_f32_16x16x32_bf16 v[112:115], a[44:47], v[156:159], v[112:115]
    v_and_b32_e64 v59, v37, v19
    v_mfma_f32_16x16x32_bf16 v[68:71], v[52:55], v[168:171], 0
    v_mfma_f32_16x16x32_bf16 v[116:119], a[76:79], v[156:159], v[116:119]
    v_and_b32_e64 v60, v38, v16
    v_mfma_f32_16x16x32_bf16 v[112:115], a[12:15], v[120:123], v[112:115]
    ds_read_b128 v[156:159], v14 offset:256
    v_and_b32_e64 v61, v38, v17
    v_mfma_f32_16x16x32_bf16 v[116:119], a[44:47], v[120:123], v[116:119]
    v_and_b32 v62, v38, v18
    s_waitcnt lgkmcnt(8)
    v_mfma_f32_16x16x32_bf16 v[116:119], a[12:15], v[124:127], v[116:119]
    ds_read_b128 v[120:123], v14 offset:3904
    s_waitcnt lgkmcnt(8)
    v_mfma_f32_16x16x32_bf16 v[88:91], a[16:19], v[128:131], v[88:91]
    ds_read_b128 v[124:127], v14 offset:3392
    buffer_load_dword v240, v4, s[4:7], s60 offen offset:0 nt
    v_mfma_f32_16x16x32_bf16 v[92:95], a[48:51], v[128:131], v[92:95]
    buffer_load_dword v241, v4, s[4:7], s60 offen offset:2048 nt
    v_and_b32 v63, v38, v19
    v_mfma_f32_16x16x32_bf16 v[96:99], a[80:83], v[128:131], v[96:99]
    buffer_load_dword v242, v4, s[4:7], s61 offen offset:0 nt
    v_mfma_f32_16x16x32_bf16 v[68:71], v[56:59], v[172:175], v[68:71]
    v_mfma_f32_16x16x32_bf16 v[100:103], a[112:115], v[128:131], v[100:103]
    buffer_load_dword v243, v4, s[4:7], s61 offen offset:2048 nt
    v_and_b32_e64 v64, v39, v16
    v_mfma_f32_16x16x32_bf16 v[104:107], a[144:147], v[128:131], v[104:107]
    v_and_b32 v65, v39, v17
    v_and_b32 v66, v39, v18
    v_mfma_f32_16x16x32_bf16 v[108:111], a[176:179], v[128:131], v[108:111]
    v_and_b32_e64 v67, v39, v19
    v_mfma_f32_16x16x32_bf16 v[68:71], v[60:63], v[176:179], v[68:71]
    v_mfma_f32_16x16x32_bf16 v[112:115], a[208:211], v[128:131], v[112:115]
    v_and_b32 v52, v40, v16
    v_and_b32 v53, v40, v17
    v_mfma_f32_16x16x32_bf16 v[116:119], a[240:243], v[128:131], v[116:119]
    v_and_b32 v54, v40, v18
    s_waitcnt lgkmcnt(8)
    v_mfma_f32_16x16x32_bf16 v[92:95], a[16:19], v[132:135], v[92:95]
    ds_read_b128 v[128:131], v14 offset:2880
    v_and_b32_e64 v55, v40, v19
    v_mfma_f32_16x16x32_bf16 v[96:99], a[48:51], v[132:135], v[96:99]
    buffer_load_dword v244, v4, s[4:7], s62 offen offset:0 nt
    v_mfma_f32_16x16x32_bf16 v[68:71], v[64:67], v[180:183], v[68:71]
    v_mfma_f32_16x16x32_bf16 v[100:103], a[80:83], v[132:135], v[100:103]
    buffer_load_dword v245, v4, s[4:7], s62 offen offset:2048 nt
    v_and_b32_e64 v56, v41, v16
    v_mfma_f32_16x16x32_bf16 v[104:107], a[112:115], v[132:135], v[104:107]
    buffer_load_dword v246, v4, s[4:7], s63 offen offset:0 nt
    v_and_b32_e64 v57, v41, v17
    v_mfma_f32_16x16x32_bf16 v[108:111], a[144:147], v[132:135], v[108:111]
    buffer_load_dword v247, v4, s[4:7], s63 offen offset:2048 nt
    v_and_b32_e64 v58, v41, v18
    v_mfma_f32_16x16x32_bf16 v[112:115], a[176:179], v[132:135], v[112:115]
    v_and_b32_e64 v59, v41, v19
    v_mfma_f32_16x16x32_bf16 v[68:71], v[52:55], v[184:187], v[68:71]
    v_mfma_f32_16x16x32_bf16 v[116:119], a[208:211], v[132:135], v[116:119]
    v_and_b32 v60, v42, v16
    s_waitcnt lgkmcnt(8)
    v_mfma_f32_16x16x32_bf16 v[96:99], a[16:19], v[136:139], v[96:99]
    ds_read_b128 v[132:135], v14 offset:2368
    v_and_b32_e64 v61, v42, v17
    v_mfma_f32_16x16x32_bf16 v[100:103], a[48:51], v[136:139], v[100:103]
    v_and_b32 v62, v42, v18
    v_and_b32 v63, v42, v19
    v_mfma_f32_16x16x32_bf16 v[104:107], a[80:83], v[136:139], v[104:107]
    v_mfma_f32_16x16x32_bf16 v[68:71], v[56:59], v[188:191], v[68:71]
    v_and_b32_e64 v64, v43, v16
    v_mfma_f32_16x16x32_bf16 v[108:111], a[112:115], v[136:139], v[108:111]
    v_and_b32 v65, v43, v17
    v_and_b32 v66, v43, v18
    v_mfma_f32_16x16x32_bf16 v[112:115], a[144:147], v[136:139], v[112:115]
    buffer_load_dwordx4 a[0:3], v6, s[24:27], 0 offen offset:0 nt
    v_and_b32_e64 v67, v43, v19
    v_mfma_f32_16x16x32_bf16 v[116:119], a[176:179], v[136:139], v[116:119]
    v_mfma_f32_16x16x32_bf16 v[68:71], v[60:63], v[192:195], v[68:71]
    s_waitcnt lgkmcnt(8)
    v_mfma_f32_16x16x32_bf16 v[100:103], a[16:19], v[140:143], v[100:103]
    ds_read_b128 v[136:139], v14 offset:1856
    v_and_b32 v52, v44, v16
    v_mfma_f32_16x16x32_bf16 v[104:107], a[48:51], v[140:143], v[104:107]
    v_and_b32 v53, v44, v17
    v_and_b32 v54, v44, v18
    v_mfma_f32_16x16x32_bf16 v[108:111], a[80:83], v[140:143], v[108:111]
    v_and_b32_e64 v55, v44, v19
    v_mfma_f32_16x16x32_bf16 v[68:71], v[64:67], v[196:199], v[68:71]
    v_mfma_f32_16x16x32_bf16 v[112:115], a[112:115], v[140:143], v[112:115]
    v_and_b32 v56, v45, v16
    v_and_b32 v57, v45, v17
    v_mfma_f32_16x16x32_bf16 v[116:119], a[144:147], v[140:143], v[116:119]
    v_and_b32 v58, v45, v18
    s_waitcnt lgkmcnt(8)
    v_mfma_f32_16x16x32_bf16 v[104:107], a[16:19], v[144:147], v[104:107]
    ds_read_b128 v[140:143], v14 offset:1344
    v_and_b32_e64 v59, v45, v19
    v_mfma_f32_16x16x32_bf16 v[108:111], a[48:51], v[144:147], v[108:111]
    s_waitcnt vmcnt(26)
    v_mfma_f32_16x16x32_bf16 v[68:71], v[52:55], v[200:203], v[68:71]
    v_and_b32 v60, v46, v16
    v_mfma_f32_16x16x32_bf16 v[112:115], a[80:83], v[144:147], v[112:115]
    v_and_b32 v61, v46, v17
    v_and_b32 v62, v46, v18
    v_mfma_f32_16x16x32_bf16 v[116:119], a[112:115], v[144:147], v[116:119]
    buffer_load_dwordx4 a[32:35], v6, s[24:27], 0 offen offset:2048 nt
    s_waitcnt lgkmcnt(7)
    v_mfma_f32_16x16x32_bf16 v[108:111], a[16:19], v[148:151], v[108:111]
    ds_read_b128 v[144:147], v14 offset:832
    v_and_b32 v63, v46, v19
    v_mfma_f32_16x16x32_bf16 v[112:115], a[48:51], v[148:151], v[112:115]
    s_waitcnt vmcnt(26)
    v_mfma_f32_16x16x32_bf16 v[68:71], v[56:59], v[204:207], v[68:71]
    v_and_b32 v64, v47, v16
    v_mfma_f32_16x16x32_bf16 v[116:119], a[80:83], v[148:151], v[116:119]
    v_and_b32_e64 v65, v47, v17
    v_mfma_f32_16x16x32_bf16 v[112:115], a[16:19], v[152:155], v[112:115]
    ds_read_b128 v[148:151], v14 offset:320
    v_and_b32_e64 v66, v47, v18
    v_mfma_f32_16x16x32_bf16 v[116:119], a[48:51], v[152:155], v[116:119]
    v_and_b32 v67, v47, v19
    s_waitcnt lgkmcnt(8)
    v_mfma_f32_16x16x32_bf16 v[116:119], a[16:19], v[156:159], v[116:119]
    ds_read_b128 v[152:155], v14 offset:3968
    s_waitcnt lgkmcnt(8)
    v_mfma_f32_16x16x32_bf16 v[88:91], a[20:23], v[120:123], v[88:91]
    ds_read_b128 v[156:159], v14 offset:3456
    s_waitcnt vmcnt(25)
    v_mfma_f32_16x16x32_bf16 v[68:71], v[60:63], v[208:211], v[68:71]
    v_mfma_f32_16x16x32_bf16 v[92:95], a[52:55], v[120:123], v[92:95]
    v_and_b32 v52, v48, v16
    v_and_b32 v53, v48, v17
    v_mfma_f32_16x16x32_bf16 v[96:99], a[84:87], v[120:123], v[96:99]
    v_and_b32 v54, v48, v18
    v_and_b32 v55, v48, v19
    v_mfma_f32_16x16x32_bf16 v[100:103], a[116:119], v[120:123], v[100:103]
    buffer_load_dwordx4 a[64:67], v6, s[24:27], s57 offen offset:0 nt
    s_waitcnt vmcnt(25)
    v_mfma_f32_16x16x32_bf16 v[68:71], v[64:67], v[212:215], v[68:71]
    v_mfma_f32_16x16x32_bf16 v[104:107], a[148:151], v[120:123], v[104:107]
    v_and_b32 v56, v49, v16
    v_and_b32_e64 v57, v49, v17
    v_mfma_f32_16x16x32_bf16 v[108:111], a[180:183], v[120:123], v[108:111]
    v_and_b32 v58, v49, v18
    v_and_b32 v59, v49, v19
    v_mfma_f32_16x16x32_bf16 v[112:115], a[212:215], v[120:123], v[112:115]
    s_waitcnt vmcnt(24)
    v_mfma_f32_16x16x32_bf16 v[68:71], v[52:55], v[216:219], v[68:71]
    v_and_b32 v60, v50, v16
    v_mfma_f32_16x16x32_bf16 v[116:119], a[244:247], v[120:123], v[116:119]
    v_and_b32 v61, v50, v17
    s_waitcnt lgkmcnt(8)
    v_mfma_f32_16x16x32_bf16 v[92:95], a[20:23], v[124:127], v[92:95]
    ds_read_b128 v[120:123], v14 offset:2944
    v_and_b32_e64 v62, v50, v18
    v_mfma_f32_16x16x32_bf16 v[96:99], a[52:55], v[124:127], v[96:99]
    v_and_b32 v63, v50, v19
    s_waitcnt vmcnt(23)
    v_mfma_f32_16x16x32_bf16 v[68:71], v[56:59], v[220:223], v[68:71]
    v_mfma_f32_16x16x32_bf16 v[100:103], a[84:87], v[124:127], v[100:103]
    v_and_b32 v64, v51, v16
    v_and_b32 v65, v51, v17
    v_mfma_f32_16x16x32_bf16 v[104:107], a[116:119], v[124:127], v[104:107]
    v_and_b32 v66, v51, v18
    v_and_b32 v67, v51, v19
    v_mfma_f32_16x16x32_bf16 v[108:111], a[148:151], v[124:127], v[108:111]
    s_waitcnt vmcnt(22)
    v_mfma_f32_16x16x32_bf16 v[68:71], v[60:63], v[224:227], v[68:71]
    v_mfma_f32_16x16x32_bf16 v[112:115], a[180:183], v[124:127], v[112:115]
    buffer_load_dwordx4 a[96:99], v6, s[24:27], s57 offen offset:2048 nt
    v_mfma_f32_16x16x32_bf16 v[116:119], a[212:215], v[124:127], v[116:119]
    s_waitcnt vmcnt(22)
    v_mfma_f32_16x16x32_bf16 v[68:71], v[64:67], v[228:231], v[68:71]
    s_waitcnt lgkmcnt(8)
    v_mfma_f32_16x16x32_bf16 v[96:99], a[20:23], v[128:131], v[96:99]
    ds_read_b128 v[124:127], v14 offset:2432
    v_mfma_f32_16x16x32_bf16 v[100:103], a[52:55], v[128:131], v[100:103]
    v_mfma_f32_16x16x32_bf16 v[104:107], a[84:87], v[128:131], v[104:107]
    v_mfma_f32_16x16x32_bf16 v[108:111], a[116:119], v[128:131], v[108:111]
    s_nop 1
    ds_write_b128 v9, v[68:71]
    v_mfma_f32_16x16x32_bf16 v[112:115], a[148:151], v[128:131], v[112:115]
    v_mfma_f32_16x16x32_bf16 v[116:119], a[180:183], v[128:131], v[116:119]
    s_waitcnt lgkmcnt(9)
    v_mfma_f32_16x16x32_bf16 v[100:103], a[20:23], v[132:135], v[100:103]
    ds_read_b128 v[128:131], v14 offset:1920
    v_mfma_f32_16x16x32_bf16 v[104:107], a[52:55], v[132:135], v[104:107]
    s_waitcnt lgkmcnt(1)
    s_barrier
    v_mfma_f32_16x16x32_bf16 v[108:111], a[84:87], v[132:135], v[108:111]
    buffer_load_dwordx4 a[128:131], v6, s[24:27], s58 offen offset:0 nt
    ds_read2st64_b32 v[68:69], v35 offset0:0 offset1:4
    v_mfma_f32_16x16x32_bf16 v[112:115], a[116:119], v[132:135], v[112:115]
    ds_read2st64_b32 v[70:71], v35 offset0:8 offset1:12
    v_mfma_f32_16x16x32_bf16 v[116:119], a[148:151], v[132:135], v[116:119]
    v_mfma_f32_16x16x32_bf16 v[104:107], a[20:23], v[136:139], v[104:107]
    ds_read_b128 v[132:135], v14 offset:1408
    v_mfma_f32_16x16x32_bf16 v[108:111], a[52:55], v[136:139], v[108:111]
    v_mfma_f32_16x16x32_bf16 v[112:115], a[84:87], v[136:139], v[112:115]
    s_waitcnt lgkmcnt(1)
    v_mfma_f32_16x16x32_bf16 v[116:119], a[116:119], v[136:139], v[116:119]
    v_add_f32_e64 v68, v68, v69
    v_mfma_f32_16x16x32_bf16 v[108:111], a[20:23], v[140:143], v[108:111]
    ds_read_b128 v[136:139], v14 offset:896
    v_add_f32_e64 v70, v70, v71
    v_mfma_f32_16x16x32_bf16 v[112:115], a[52:55], v[140:143], v[112:115]
    v_mov_b32 v69, v10
    v_add_f32 v68, v68, v70
    v_mfma_f32_16x16x32_bf16 v[116:119], a[84:87], v[140:143], v[116:119]
    buffer_store_dwordx2 v[68:69], v34, s[32:35], s93 offen sc1
    v_mfma_f32_16x16x32_bf16 v[112:115], a[20:23], v[144:147], v[112:115]
    ds_read_b128 v[140:143], v14 offset:384
    buffer_load_dwordx4 a[160:163], v6, s[24:27], s58 offen offset:2048 nt
    v_mfma_f32_16x16x32_bf16 v[116:119], a[52:55], v[144:147], v[116:119]
    v_lshrrev_b32_e64 v22, 1, v1
    v_mfma_f32_16x16x32_bf16 v[116:119], a[20:23], v[148:151], v[116:119]
    ds_read_b128 v[144:147], v14 offset:4032
    v_mfma_f32_16x16x32_bf16 v[88:91], a[24:27], v[152:155], v[88:91]
    ds_read_b128 v[148:151], v14 offset:3520
    v_min_u32_e64 v22, 27, v22
    v_mfma_f32_16x16x32_bf16 v[92:95], a[56:59], v[152:155], v[92:95]
    v_and_b32_e64 v23, 1, v1
    v_mul_u32_u24 v24, 229376, v23
    v_mfma_f32_16x16x32_bf16 v[96:99], a[88:91], v[152:155], v[96:99]
    v_lshl_add_u32 v24, v22, 4, v24
    s_mul_i32 s100, s54, 448
    v_mfma_f32_16x16x32_bf16 v[100:103], a[120:123], v[152:155], v[100:103]
    s_add_u32 s100, s100, 262144
    v_add_u32_e64 v24, s100, v24
    v_mfma_f32_16x16x32_bf16 v[104:107], a[152:155], v[152:155], v[104:107]
    v_add_u32 v25, 114688, v24
    v_mul_u32_u24_e64 v26, 37, v22
    v_mfma_f32_16x16x32_bf16 v[108:111], a[184:187], v[152:155], v[108:111]
    v_lshrrev_b32 v26, 8, v26
    v_add_u32 v26, v26, v22
    v_mfma_f32_16x16x32_bf16 v[112:115], a[216:219], v[152:155], v[112:115]
    v_lshlrev_b32_e64 v26, 2, v26
    v_lshl_add_u32 v26, v23, 7, v26
    v_mfma_f32_16x16x32_bf16 v[116:119], a[248:251], v[152:155], v[116:119]
    buffer_load_dwordx4 a[192:195], v6, s[24:27], s59 offen offset:0 nt
    v_mfma_f32_16x16x32_bf16 v[92:95], a[24:27], v[156:159], v[92:95]
    ds_read_b128 v[152:155], v14 offset:3008
    s_lshl_b32 s91, s89, 11
    v_mfma_f32_16x16x32_bf16 v[96:99], a[56:59], v[156:159], v[96:99]
    s_add_u32 s91, s91, 1048576
    s_lshl_b32 s46, s50, 8
    v_mfma_f32_16x16x32_bf16 v[100:103], a[88:91], v[156:159], v[100:103]
    v_lshlrev_b32_e64 v253, 7, v2
    s_add_u32 s46, s46, 55936
    v_mfma_f32_16x16x32_bf16 v[104:107], a[120:123], v[156:159], v[104:107]
    buffer_load_dword v253, v253, s[32:35], s91 offen sc1
    v_add_u32_e64 v26, s46, v26
    v_mfma_f32_16x16x32_bf16 v[108:111], a[152:155], v[156:159], v[108:111]
    v_and_b32_e64 v22, 3, v1
    v_lshl_add_u32 v29, v22, 4, v5
    v_mfma_f32_16x16x32_bf16 v[112:115], a[184:187], v[156:159], v[112:115]
    v_lshlrev_b32_e64 v27, 14, v2
    v_lshl_add_u32 v27, v3, 4, v27
    v_mfma_f32_16x16x32_bf16 v[116:119], a[216:219], v[156:159], v[116:119]
    s_lshl_b32 s100, s54, 6
    v_mfma_f32_16x16x32_bf16 v[96:99], a[24:27], v[120:123], v[96:99]
    ds_read_b128 v[156:159], v14 offset:2496
    s_lshl_b32 s101, s48, 18
    v_mfma_f32_16x16x32_bf16 v[100:103], a[56:59], v[120:123], v[100:103]
    s_add_u32 s101, s101, 1048576
    s_add_u32 s100, s100, s101
    v_mfma_f32_16x16x32_bf16 v[104:107], a[88:91], v[120:123], v[104:107]
    v_add_u32 v27, s100, v27
    s_lshl_b32 s100, s49, 13
    v_mfma_f32_16x16x32_bf16 v[108:111], a[120:123], v[120:123], v[108:111]
    s_add_u32 s100, s100, s101
    v_add_u32_e64 v28, s100, v8
    v_mfma_f32_16x16x32_bf16 v[112:115], a[152:155], v[120:123], v[112:115]
    s_mov_b32 s40, 0
    s_mov_b32 s41, 0
    v_mfma_f32_16x16x32_bf16 v[116:119], a[184:187], v[120:123], v[116:119]
    s_not_b32 s96, s98
    v_mfma_f32_16x16x32_bf16 v[100:103], a[24:27], v[124:127], v[100:103]
    ds_read_b128 v[120:123], v14 offset:1984
    s_and_b32 s96, s96, 0x7ff
    v_mfma_f32_16x16x32_bf16 v[104:107], a[56:59], v[124:127], v[104:107]
    s_not_b32 s97, s99
    s_and_b32 s97, s97, 0x7ff
    v_mfma_f32_16x16x32_bf16 v[108:111], a[88:91], v[124:127], v[108:111]
    v_mov_b32 v32, 1.0
    v_mov_b32 v33, 1.0
    v_mfma_f32_16x16x32_bf16 v[112:115], a[120:123], v[124:127], v[112:115]
    s_mov_b32 s56, 57344
    v_mfma_f32_16x16x32_bf16 v[116:119], a[152:155], v[124:127], v[116:119]
    v_mfma_f32_16x16x32_bf16 v[104:107], a[24:27], v[128:131], v[104:107]
    ds_read_b128 v[124:127], v14 offset:1472
    v_mfma_f32_16x16x32_bf16 v[108:111], a[56:59], v[128:131], v[108:111]
    v_mfma_f32_16x16x32_bf16 v[112:115], a[88:91], v[128:131], v[112:115]
    v_mfma_f32_16x16x32_bf16 v[116:119], a[120:123], v[128:131], v[116:119]
    s_waitcnt lgkmcnt(7)
    v_mfma_f32_16x16x32_bf16 v[108:111], a[24:27], v[132:135], v[108:111]
    ds_read_b128 v[128:131], v14 offset:960
    v_mfma_f32_16x16x32_bf16 v[112:115], a[56:59], v[132:135], v[112:115]
    v_mfma_f32_16x16x32_bf16 v[116:119], a[88:91], v[132:135], v[116:119]
    v_mfma_f32_16x16x32_bf16 v[112:115], a[24:27], v[136:139], v[112:115]
    ds_read_b128 v[132:135], v14 offset:448
    buffer_load_dword v254, v11, s[32:35], s53 offen offset:128 sc1
    v_mfma_f32_16x16x32_bf16 v[116:119], a[56:59], v[136:139], v[116:119]
    s_waitcnt lgkmcnt(8)
    v_mfma_f32_16x16x32_bf16 v[116:119], a[24:27], v[140:143], v[116:119]
    s_waitcnt lgkmcnt(7)
    v_mfma_f32_16x16x32_bf16 v[88:91], a[28:31], v[144:147], v[88:91]
    v_mfma_f32_16x16x32_bf16 v[92:95], a[60:63], v[144:147], v[92:95]
    v_mfma_f32_16x16x32_bf16 v[96:99], a[92:95], v[144:147], v[96:99]
    v_mfma_f32_16x16x32_bf16 v[100:103], a[124:127], v[144:147], v[100:103]
    v_mfma_f32_16x16x32_bf16 v[104:107], a[156:159], v[144:147], v[104:107]
    v_mfma_f32_16x16x32_bf16 v[108:111], a[188:191], v[144:147], v[108:111]
    v_mfma_f32_16x16x32_bf16 v[112:115], a[220:223], v[144:147], v[112:115]
    v_mfma_f32_16x16x32_bf16 v[116:119], a[252:255], v[144:147], v[116:119]
    s_waitcnt lgkmcnt(6)
    v_mfma_f32_16x16x32_bf16 v[92:95], a[28:31], v[148:151], v[92:95]
    v_mfma_f32_16x16x32_bf16 v[96:99], a[60:63], v[148:151], v[96:99]
    v_mfma_f32_16x16x32_bf16 v[100:103], a[92:95], v[148:151], v[100:103]
    v_mfma_f32_16x16x32_bf16 v[104:107], a[124:127], v[148:151], v[104:107]
    v_mfma_f32_16x16x32_bf16 v[108:111], a[156:159], v[148:151], v[108:111]
    v_mfma_f32_16x16x32_bf16 v[112:115], a[188:191], v[148:151], v[112:115]
    v_mfma_f32_16x16x32_bf16 v[116:119], a[220:223], v[148:151], v[116:119]
    s_waitcnt lgkmcnt(5)
    v_mfma_f32_16x16x32_bf16 v[96:99], a[28:31], v[152:155], v[96:99]
    v_mfma_f32_16x16x32_bf16 v[100:103], a[60:63], v[152:155], v[100:103]
    v_mfma_f32_16x16x32_bf16 v[104:107], a[92:95], v[152:155], v[104:107]
    v_mfma_f32_16x16x32_bf16 v[108:111], a[124:127], v[152:155], v[108:111]
    v_mfma_f32_16x16x32_bf16 v[112:115], a[156:159], v[152:155], v[112:115]
    v_mfma_f32_16x16x32_bf16 v[116:119], a[188:191], v[152:155], v[116:119]
    s_waitcnt lgkmcnt(4)
    v_mfma_f32_16x16x32_bf16 v[100:103], a[28:31], v[156:159], v[100:103]
    v_mfma_f32_16x16x32_bf16 v[104:107], a[60:63], v[156:159], v[104:107]
    v_mfma_f32_16x16x32_bf16 v[108:111], a[92:95], v[156:159], v[108:111]
    v_mfma_f32_16x16x32_bf16 v[112:115], a[124:127], v[156:159], v[112:115]
    v_mfma_f32_16x16x32_bf16 v[116:119], a[156:159], v[156:159], v[116:119]
    s_waitcnt lgkmcnt(3)
    v_mfma_f32_16x16x32_bf16 v[104:107], a[28:31], v[120:123], v[104:107]
    v_mfma_f32_16x16x32_bf16 v[108:111], a[60:63], v[120:123], v[108:111]
    v_mfma_f32_16x16x32_bf16 v[112:115], a[92:95], v[120:123], v[112:115]
    v_mfma_f32_16x16x32_bf16 v[116:119], a[124:127], v[120:123], v[116:119]
    s_waitcnt lgkmcnt(1)
    v_mfma_f32_16x16x32_bf16 v[108:111], a[28:31], v[124:127], v[108:111]
    v_mfma_f32_16x16x32_bf16 v[112:115], a[60:63], v[124:127], v[112:115]
    v_mfma_f32_16x16x32_bf16 v[116:119], a[92:95], v[124:127], v[116:119]
    v_mfma_f32_16x16x32_bf16 v[112:115], a[28:31], v[128:131], v[112:115]
    v_mfma_f32_16x16x32_bf16 v[116:119], a[60:63], v[128:131], v[116:119]
    s_waitcnt lgkmcnt(0)
    v_mfma_f32_16x16x32_bf16 v[116:119], a[28:31], v[132:135], v[116:119]
    v_cvt_pk_bf16_f32 v120, v88, v89
    v_cvt_pk_bf16_f32 v121, v90, v91
    v_cvt_pk_bf16_f32 v122, v92, v93
    v_cvt_pk_bf16_f32 v123, v94, v95
    v_cvt_pk_bf16_f32 v124, v96, v97
    v_cvt_pk_bf16_f32 v125, v98, v99
    v_cvt_pk_bf16_f32 v126, v100, v101
    v_cvt_pk_bf16_f32 v127, v102, v103
    v_cvt_pk_bf16_f32 v128, v104, v105
    v_cvt_pk_bf16_f32 v129, v106, v107
    v_cvt_pk_bf16_f32 v130, v108, v109
    v_cvt_pk_bf16_f32 v131, v110, v111
    v_cvt_pk_bf16_f32 v132, v112, v113
    v_cvt_pk_bf16_f32 v133, v114, v115
    v_cvt_pk_bf16_f32 v134, v116, v117
    v_cvt_pk_bf16_f32 v135, v118, v119
    v_min_u32 v120, -2, v120
    v_min_u32 v121, -2, v121
    v_min_u32 v122, -2, v122
    v_min_u32 v123, -2, v123
    v_min_u32 v124, -2, v124
    v_min_u32 v125, -2, v125
    v_min_u32 v126, -2, v126
    v_min_u32 v127, -2, v127
    v_min_u32 v128, -2, v128
    v_min_u32 v129, -2, v129
    v_min_u32 v130, -2, v130
    v_min_u32 v131, -2, v131
    v_min_u32 v132, -2, v132
    v_min_u32 v133, -2, v133
    v_min_u32 v134, -2, v134
    v_min_u32 v135, -2, v135
    v_permlane16_swap_b32 v120, v122
    v_permlane16_swap_b32 v121, v123
    v_permlane16_swap_b32 v124, v126
    v_permlane16_swap_b32 v125, v127
    v_permlane16_swap_b32 v128, v130
    v_permlane16_swap_b32 v129, v131
    v_permlane16_swap_b32 v132, v134
    v_permlane16_swap_b32 v133, v135
    ds_write_b128 v250, v[120:123] offset:0
    ds_write_b128 v250, v[124:127] offset:4608
    ds_write_b128 v250, v[128:131] offset:9216
    ds_write_b128 v250, v[132:135] offset:13824
    s_waitcnt lgkmcnt(0)
    s_barrier
    ds_read_b128 v[136:139], v252 offset:0
    ds_read_b128 v[140:143], v252 offset:4608
    ds_read_b128 v[144:147], v252 offset:9216
    ds_read_b128 v[148:151], v252 offset:13824
    s_waitcnt lgkmcnt(3)
    buffer_store_dwordx4 v[136:139], v12, s[28:31], 0 offen
    s_mov_b32 s91, 1048576
    s_waitcnt lgkmcnt(2)
    buffer_store_dwordx4 v[140:143], v12, s[28:31], s91 offen
    s_mov_b32 s91, 2097152
    s_waitcnt lgkmcnt(1)
    buffer_store_dwordx4 v[144:147], v12, s[28:31], s91 offen
    s_mov_b32 s91, 3145728
    s_waitcnt lgkmcnt(0)
    buffer_store_dwordx4 v[148:151], v12, s[28:31], s91 offen
    s_waitcnt vmcnt(14)
L_g2_chk:
    v_cmp_ne_u32 vcc, s51, v249
    s_nop 0
    s_cmp_lg_u64 vcc, 0
    s_cbranch_scc1 L_g2_re
    v_and_b32 v22, s1, v248
    v_lshlrev_b32 v23, 16, v248
    v_rcp_f32 v22, v22
    v_lshlrev_b32 v30, 16, v21
    v_and_b32 v31, s1, v21
    v_mul_f32 v23, v23, v22
    buffer_load_dwordx4 v[104:107], v24, s[32:35], 0 offen sc1
    buffer_load_dwordx4 v[108:111], v24, s[32:35], s56 offen sc1
    buffer_load_dwordx4 v[112:115], v25, s[32:35], 0 offen sc1
    buffer_load_dwordx4 v[116:119], v25, s[32:35], s56 offen sc1
    v_readlane_b32 s64, v22, 0
    v_readlane_b32 s65, v23, 0
    v_readlane_b32 s66, v22, 1
    v_readlane_b32 s67, v23, 1
    v_readlane_b32 s68, v22, 2
    v_readlane_b32 s69, v23, 2
    v_readlane_b32 s70, v22, 3
    v_readlane_b32 s71, v23, 3
    v_readlane_b32 s72, v22, 4
    v_readlane_b32 s73, v23, 4
    v_readlane_b32 s74, v22, 5
    v_readlane_b32 s75, v23, 5
    v_readlane_b32 s76, v22, 6
    v_readlane_b32 s77, v23, 6
    v_readlane_b32 s78, v22, 7
    v_readlane_b32 s79, v23, 7
    v_readlane_b32 s80, v22, 8
    v_readlane_b32 s81, v23, 8
    v_readlane_b32 s82, v22, 9
    v_readlane_b32 s83, v23, 9
    v_readlane_b32 s84, v22, 10
    v_readlane_b32 s85, v23, 10
    v_readlane_b32 s86, v22, 11
    v_readlane_b32 s87, v23, 11
    v_readlane_b32 s88, v22, 12
    v_readlane_b32 s89, v23, 12
    v_readlane_b32 s90, v22, 13
    v_readlane_b32 s91, v23, 13
    v_readlane_b32 s92, v22, 14
    v_readlane_b32 s93, v23, 14
    v_readlane_b32 s94, v22, 15
    v_readlane_b32 s95, v23, 15
    v_lshlrev_b32 v136, 16, v232
    v_and_b32 v137, s1, v232
    v_lshlrev_b32 v138, 16, v233
    v_and_b32 v139, s1, v233
    v_lshlrev_b32 v140, 16, v234
    v_and_b32 v141, s1, v234
    v_lshlrev_b32 v142, 16, v235
    v_and_b32 v143, s1, v235
    v_lshlrev_b32 v144, 16, v236
    v_and_b32 v145, s1, v236
    v_lshlrev_b32 v146, 16, v237
    v_and_b32 v147, s1, v237
    v_lshlrev_b32 v148, 16, v238
    v_and_b32 v149, s1, v238
    v_lshlrev_b32 v150, 16, v239
    v_and_b32 v151, s1, v239
    v_lshlrev_b32 v152, 16, v240
    v_and_b32 v153, s1, v240
    v_lshlrev_b32 v154, 16, v241
    v_and_b32 v155, s1, v241
    v_lshlrev_b32 v156, 16, v242
    v_and_b32 v157, s1, v242
    v_lshlrev_b32 v158, 16, v243
    v_and_b32 v159, s1, v243
    v_lshlrev_b32 v160, 16, v244
    v_and_b32 v161, s1, v244
    v_lshlrev_b32 v162, 16, v245
    v_and_b32 v163, s1, v245
    v_lshlrev_b32 v164, 16, v246
    v_and_b32 v165, s1, v246
    v_lshlrev_b32 v166, 16, v247
    v_and_b32 v167, s1, v247
    v_pk_fma_f32 v[168:169], v[136:137], s[64:65], s[64:65] op_sel:[0,0,1] op_sel_hi:[1,0,1] neg_lo:[0,0,1] neg_hi:[0,0,1]
    v_pk_fma_f32 v[170:171], v[138:139], s[66:67], s[66:67] op_sel:[0,0,1] op_sel_hi:[1,0,1] neg_lo:[0,0,1] neg_hi:[0,0,1]
    v_pk_fma_f32 v[172:173], v[140:141], s[68:69], s[68:69] op_sel:[0,0,1] op_sel_hi:[1,0,1] neg_lo:[0,0,1] neg_hi:[0,0,1]
    v_pk_fma_f32 v[174:175], v[142:143], s[70:71], s[70:71] op_sel:[0,0,1] op_sel_hi:[1,0,1] neg_lo:[0,0,1] neg_hi:[0,0,1]
    v_pk_fma_f32 v[176:177], v[144:145], s[72:73], s[72:73] op_sel:[0,0,1] op_sel_hi:[1,0,1] neg_lo:[0,0,1] neg_hi:[0,0,1]
    v_pk_fma_f32 v[178:179], v[146:147], s[74:75], s[74:75] op_sel:[0,0,1] op_sel_hi:[1,0,1] neg_lo:[0,0,1] neg_hi:[0,0,1]
    v_pk_fma_f32 v[180:181], v[148:149], s[76:77], s[76:77] op_sel:[0,0,1] op_sel_hi:[1,0,1] neg_lo:[0,0,1] neg_hi:[0,0,1]
    v_pk_fma_f32 v[182:183], v[150:151], s[78:79], s[78:79] op_sel:[0,0,1] op_sel_hi:[1,0,1] neg_lo:[0,0,1] neg_hi:[0,0,1]
    v_pk_fma_f32 v[184:185], v[152:153], s[80:81], s[80:81] op_sel:[0,0,1] op_sel_hi:[1,0,1] neg_lo:[0,0,1] neg_hi:[0,0,1]
    v_pk_fma_f32 v[186:187], v[154:155], s[82:83], s[82:83] op_sel:[0,0,1] op_sel_hi:[1,0,1] neg_lo:[0,0,1] neg_hi:[0,0,1]
    v_pk_fma_f32 v[188:189], v[156:157], s[84:85], s[84:85] op_sel:[0,0,1] op_sel_hi:[1,0,1] neg_lo:[0,0,1] neg_hi:[0,0,1]
    v_pk_fma_f32 v[190:191], v[158:159], s[86:87], s[86:87] op_sel:[0,0,1] op_sel_hi:[1,0,1] neg_lo:[0,0,1] neg_hi:[0,0,1]
    v_pk_fma_f32 v[192:193], v[160:161], s[88:89], s[88:89] op_sel:[0,0,1] op_sel_hi:[1,0,1] neg_lo:[0,0,1] neg_hi:[0,0,1]
    v_pk_fma_f32 v[194:195], v[162:163], s[90:91], s[90:91] op_sel:[0,0,1] op_sel_hi:[1,0,1] neg_lo:[0,0,1] neg_hi:[0,0,1]
    v_pk_fma_f32 v[196:197], v[164:165], s[92:93], s[92:93] op_sel:[0,0,1] op_sel_hi:[1,0,1] neg_lo:[0,0,1] neg_hi:[0,0,1]
    v_pk_fma_f32 v[198:199], v[166:167], s[94:95], s[94:95] op_sel:[0,0,1] op_sel_hi:[1,0,1] neg_lo:[0,0,1] neg_hi:[0,0,1]
    s_waitcnt vmcnt(8)
L_poll1_chk:
    v_cmp_ne_u32 vcc, s51, v254
    s_nop 0
    s_cmp_lg_u64 vcc, 0
    s_cbranch_scc1 L_poll1_re
    buffer_load_dwordx4 v[88:91], v29, s[28:31], 0 offen offset:0 sc1
    buffer_load_dwordx4 v[96:99], v29, s[28:31], s60 offen offset:0 sc1
    buffer_load_dwordx4 v[92:95], v29, s[28:31], 0 offen offset:16 sc1
    buffer_load_dwordx4 v[100:103], v29, s[28:31], s60 offen offset:16 sc1
    v_lshlrev_b32 v230, 16, v72
    v_and_b32 v228, s1, v72
    v_lshlrev_b32 v226, 16, v73
    v_and_b32 v224, s1, v73
    v_lshlrev_b32 v222, 16, v74
    v_and_b32 v220, s1, v74
    v_lshlrev_b32 v218, 16, v75
    v_and_b32 v216, s1, v75
    v_lshlrev_b32 v214, 16, v76
    v_and_b32 v212, s1, v76
    v_lshlrev_b32 v210, 16, v77
    v_and_b32 v208, s1, v77
    v_lshlrev_b32 v206, 16, v78
    v_and_b32 v204, s1, v78
    v_lshlrev_b32 v202, 16, v79
    v_and_b32 v200, s1, v79
    v_lshlrev_b32 v231, 16, v80
    v_and_b32 v229, s1, v80
    v_lshlrev_b32 v227, 16, v81
    v_and_b32 v225, s1, v81
    v_lshlrev_b32 v223, 16, v82
    v_and_b32 v221, s1, v82
    v_lshlrev_b32 v219, 16, v83
    v_and_b32 v217, s1, v83
    v_lshlrev_b32 v215, 16, v84
    v_and_b32 v213, s1, v84
    v_lshlrev_b32 v211, 16, v85
    v_and_b32 v209, s1, v85
    v_lshlrev_b32 v207, 16, v86
    v_and_b32 v205, s1, v86
    v_lshlrev_b32 v203, 16, v87
    v_and_b32_e64 v201, s1, v87
    v_pk_fma_f32 v[200:201], v[200:201], v[30:31], v[32:33]
    v_pk_fma_f32 v[202:203], v[202:203], v[30:31], v[32:33]
    v_pk_fma_f32 v[204:205], v[204:205], v[30:31], v[32:33]
    v_pk_fma_f32 v[206:207], v[206:207], v[30:31], v[32:33]
    v_pk_fma_f32 v[208:209], v[208:209], v[30:31], v[32:33]
    v_pk_fma_f32 v[210:211], v[210:211], v[30:31], v[32:33]
    v_pk_fma_f32 v[212:213], v[212:213], v[30:31], v[32:33]
    v_pk_fma_f32 v[214:215], v[214:215], v[30:31], v[32:33]
    v_pk_fma_f32 v[216:217], v[216:217], v[30:31], v[32:33]
    v_pk_fma_f32 v[218:219], v[218:219], v[30:31], v[32:33]
    v_pk_fma_f32 v[220:221], v[220:221], v[30:31], v[32:33]
    v_pk_fma_f32 v[222:223], v[222:223], v[30:31], v[32:33]
    v_pk_fma_f32 v[224:225], v[224:225], v[30:31], v[32:33]
    v_pk_fma_f32 v[226:227], v[226:227], v[30:31], v[32:33]
    v_pk_fma_f32 v[228:229], v[228:229], v[30:31], v[32:33]
    v_pk_fma_f32 v[230:231], v[230:231], v[30:31], v[32:33]
    v_pk_fma_f32 v[200:201], v[200:201], v[168:169], v[136:137]
    v_pk_fma_f32 v[202:203], v[202:203], v[170:171], v[138:139]
    v_pk_fma_f32 v[204:205], v[204:205], v[172:173], v[140:141]
    v_pk_fma_f32 v[206:207], v[206:207], v[174:175], v[142:143]
    v_pk_fma_f32 v[208:209], v[208:209], v[176:177], v[144:145]
    v_pk_fma_f32 v[210:211], v[210:211], v[178:179], v[146:147]
    v_pk_fma_f32 v[212:213], v[212:213], v[180:181], v[148:149]
    v_pk_fma_f32 v[214:215], v[214:215], v[182:183], v[150:151]
    v_pk_fma_f32 v[216:217], v[216:217], v[184:185], v[152:153]
    v_pk_fma_f32 v[218:219], v[218:219], v[186:187], v[154:155]
    v_pk_fma_f32 v[220:221], v[220:221], v[188:189], v[156:157]
    v_pk_fma_f32 v[222:223], v[222:223], v[190:191], v[158:159]
    v_pk_fma_f32 v[224:225], v[224:225], v[192:193], v[160:161]
    v_pk_fma_f32 v[226:227], v[226:227], v[194:195], v[162:163]
    v_pk_fma_f32 v[228:229], v[228:229], v[196:197], v[164:165]
    v_pk_fma_f32 v[230:231], v[230:231], v[198:199], v[166:167]
    s_waitcnt vmcnt(4)
L_g3chk:
    v_xor_b32 v36, s51, v105
    v_xor_b32 v37, s52, v107
    v_xor_b32 v38, s51, v109
    v_xor_b32 v39, s52, v111
    v_xor_b32 v40, s51, v113
    v_xor_b32 v41, s52, v115
    v_xor_b32 v42, s51, v117
    v_xor_b32_e64 v43, s52, v119
    v_or3_b32 v22, v36, v37, v38
    v_or3_b32 v23, v39, v40, v41
    v_or3_b32 v22, v22, v42, v43
    v_or_b32 v22, v22, v23
    v_cmp_ne_u32 vcc, 0, v22
    s_nop 0
    s_cmp_lg_u64 vcc, 0
    s_cbranch_scc1 L_g3bad
    v_add_f32 v104, v104, v108
    v_add_f32 v112, v112, v116
    v_add_f32 v106, v106, v110
    v_add_f32 v114, v114, v118
    v_and_b32 v23, 1, v1
    v_add_f32 v104, v104, v112
    v_add_f32 v105, v106, v114
    v_cmp_eq_u32 vcc, 1, v23
    v_mul_f32 v106, 0xbfb8aa3b, v104
    v_mul_f32 v107, 0xbfb8aa3b, v105
    v_exp_f32 v106, v106
    v_exp_f32 v107, v107
    v_add_f32 v106, 1.0, v106
    v_add_f32 v107, 1.0, v107
    v_rcp_f32 v106, v106
    v_rcp_f32 v107, v107
    v_mul_f32 v106, v104, v106
    v_mul_f32 v107, v105, v107
    v_cndmask_b32 v104, v106, v104, vcc
    v_cndmask_b32 v105, v107, v105, vcc
    v_lshrrev_b32 v22, 3, v2
    v_lshlrev_b32_e64 v22, 7, v22
    v_mul_f32_dpp v106, v104, v104 quad_perm:[1,0,3,2] row_mask:0xf bank_mask:0xf
    v_mul_f32_dpp v107, v105, v105 quad_perm:[1,0,3,2] row_mask:0xf bank_mask:0xf
    v_cndmask_b32 v106, v106, v107, vcc
    v_cvt_pk_bf16_f32 v106, v106, v106
    ds_write_b32 v26, v106
    v_lshl_add_u32 v22, v3, 5, v22
    v_add_u32 v22, s46, v22
    ds_read_b128 v[104:107], v22
    ds_read_b128 v[108:111], v22 offset:16
    v_mov_b32 v113, s51
    v_mov_b32 v115, s52
    v_mov_b32 v117, s51
    v_mov_b32 v119, s52
    s_waitcnt lgkmcnt(1)
    v_and_b32 v120, v104, v16
    v_and_b32 v121, v104, v17
    v_and_b32 v122, v104, v18
    v_and_b32 v123, v104, v19
    v_and_b32 v124, v105, v16
    v_and_b32 v125, v105, v17
    v_and_b32 v126, v105, v18
    v_and_b32_e64 v127, v105, v19
    v_mfma_f32_16x16x32_bf16 v[68:71], v[120:123], a[0:3], 0
    v_and_b32 v128, v106, v16
    v_and_b32 v129, v106, v17
    v_and_b32 v130, v106, v18
    v_and_b32 v131, v106, v19
    v_mfma_f32_16x16x32_bf16 v[68:71], v[124:127], a[32:35], v[68:71]
    v_and_b32 v132, v107, v16
    v_and_b32 v133, v107, v17
    v_and_b32 v134, v107, v18
    v_and_b32 v135, v107, v19
    v_mfma_f32_16x16x32_bf16 v[68:71], v[128:131], a[64:67], v[68:71]
    s_waitcnt lgkmcnt(0)
    v_and_b32 v120, v108, v16
    v_and_b32 v121, v108, v17
    v_and_b32 v122, v108, v18
    v_and_b32_e64 v123, v108, v19
    v_mfma_f32_16x16x32_bf16 v[68:71], v[132:135], a[96:99], v[68:71]
    v_and_b32 v124, v109, v16
    v_and_b32 v125, v109, v17
    v_and_b32 v126, v109, v18
    v_and_b32 v127, v109, v19
    v_mfma_f32_16x16x32_bf16 v[68:71], v[120:123], a[128:131], v[68:71]
    v_and_b32 v128, v110, v16
    v_and_b32 v129, v110, v17
    v_and_b32 v130, v110, v18
    v_and_b32 v131, v110, v19
    v_mfma_f32_16x16x32_bf16 v[68:71], v[124:127], a[160:163], v[68:71]
    s_nop 0
    v_mfma_f32_16x16x32_bf16 v[68:71], v[128:131], a[192:195], v[68:71]
    s_mov_b32 s40, 1
    s_nop 6
    v_mov_b32 v112, v68
    v_mov_b32 v114, v69
    v_mov_b32 v116, v70
    v_mov_b32 v118, v71
    s_nop 0
    v_permlane16_swap_b32 v112, v116
    v_permlane16_swap_b32 v114, v118
    buffer_store_dwordx4 v[112:115], v27, s[32:35], 0 offen
    buffer_store_dwordx4 v[116:119], v27, s[32:35], s58 offen
    s_cmp_lg_u32 s41, 0
    s_cbranch_scc1 L_fin
    s_waitcnt vmcnt(2)
L_y:
L_y_chk:
    v_max3_u32 v22, v88, v89, v90
    v_max3_u32 v23, v91, v92, v93
    v_max3_u32 v22, v22, v94, v95
    v_max3_u32 v23, v23, v96, v97
    v_max3_u32 v22, v22, v98, v99
    v_max3_u32 v23, v23, v100, v101
    v_max3_u32 v22, v22, v102, v103
    v_max_u32 v22, v22, v23
    v_cmp_eq_u32 vcc, -1, v22
    s_nop 0
    s_cmp_lg_u64 vcc, 0
    s_cbranch_scc1 L_y_re
    s_lshr_b32 s100, s96, 4
    s_lshr_b32 s101, s97, 4
    s_cmp_eq_u32 s100, s54
    s_cbranch_scc1 L_owner
    s_cmp_eq_u32 s101, s54
    s_cbranch_scc1 L_owner
    v_lshlrev_b32 v36, 16, v88
    v_and_b32 v38, s1, v88
    v_lshlrev_b32 v40, 16, v89
    v_and_b32 v42, s1, v89
    v_lshlrev_b32 v44, 16, v90
    v_and_b32 v46, s1, v90
    v_lshlrev_b32 v48, 16, v91
    v_and_b32 v50, s1, v91
    v_lshlrev_b32 v37, 16, v96
    v_and_b32 v39, s1, v96
    v_lshlrev_b32 v41, 16, v97
    v_and_b32 v43, s1, v97
    v_lshlrev_b32 v45, 16, v98
    v_and_b32 v47, s1, v98
    v_lshlrev_b32 v49, 16, v99
    v_and_b32 v51, s1, v99
    v_pk_fma_f32 v[200:201], v[36:37], v[168:169], v[200:201]
    v_pk_fma_f32 v[202:203], v[38:39], v[170:171], v[202:203]
    v_pk_fma_f32 v[204:205], v[40:41], v[172:173], v[204:205]
    v_pk_fma_f32 v[206:207], v[42:43], v[174:175], v[206:207]
    v_pk_fma_f32 v[208:209], v[44:45], v[176:177], v[208:209]
    v_pk_fma_f32 v[210:211], v[46:47], v[178:179], v[210:211]
    v_pk_fma_f32 v[212:213], v[48:49], v[180:181], v[212:213]
    v_pk_fma_f32 v[214:215], v[50:51], v[182:183], v[214:215]
    v_cvt_pk_bf16_f32 v232, v200, v201
    buffer_store_dword v232, v4, s[28:31], 0 offen offset:0
    v_cvt_pk_bf16_f32 v233, v202, v203
    buffer_store_dword v233, v4, s[28:31], 0 offen offset:2048
    v_cvt_pk_bf16_f32 v234, v204, v205
    buffer_store_dword v234, v4, s[28:31], s57 offen offset:0
    v_cvt_pk_bf16_f32 v235, v206, v207
    buffer_store_dword v235, v4, s[28:31], s57 offen offset:2048
    v_cvt_pk_bf16_f32 v236, v208, v209
    buffer_store_dword v236, v4, s[28:31], s58 offen offset:0
    v_cvt_pk_bf16_f32 v237, v210, v211
    buffer_store_dword v237, v4, s[28:31], s58 offen offset:2048
    v_cvt_pk_bf16_f32 v238, v212, v213
    buffer_store_dword v238, v4, s[28:31], s59 offen offset:0
    v_cvt_pk_bf16_f32 v239, v214, v215
    buffer_store_dword v239, v4, s[28:31], s59 offen offset:2048
    v_lshlrev_b32 v36, 16, v92
    v_and_b32 v38, s1, v92
    v_lshlrev_b32 v40, 16, v93
    v_and_b32 v42, s1, v93
    v_lshlrev_b32 v44, 16, v94
    v_and_b32 v46, s1, v94
    v_lshlrev_b32 v48, 16, v95
    v_and_b32 v50, s1, v95
    v_lshlrev_b32 v37, 16, v100
    v_and_b32 v39, s1, v100
    v_lshlrev_b32 v41, 16, v101
    v_and_b32 v43, s1, v101
    v_lshlrev_b32 v45, 16, v102
    v_and_b32 v47, s1, v102
    v_lshlrev_b32 v49, 16, v103
    v_and_b32 v51, s1, v103
    v_pk_fma_f32 v[216:217], v[36:37], v[184:185], v[216:217]
    v_pk_fma_f32 v[218:219], v[38:39], v[186:187], v[218:219]
    v_pk_fma_f32 v[220:221], v[40:41], v[188:189], v[220:221]
    v_pk_fma_f32 v[222:223], v[42:43], v[190:191], v[222:223]
    v_pk_fma_f32 v[224:225], v[44:45], v[192:193], v[224:225]
    v_pk_fma_f32 v[226:227], v[46:47], v[194:195], v[226:227]
    v_pk_fma_f32 v[228:229], v[48:49], v[196:197], v[228:229]
    v_pk_fma_f32 v[230:231], v[50:51], v[198:199], v[230:231]
    v_cvt_pk_bf16_f32 v240, v216, v217
    buffer_store_dword v240, v4, s[28:31], s60 offen offset:0
    v_cvt_pk_bf16_f32 v241, v218, v219
    buffer_store_dword v241, v4, s[28:31], s60 offen offset:2048
    v_cvt_pk_bf16_f32 v242, v220, v221
    buffer_store_dword v242, v4, s[28:31], s61 offen offset:0
    v_cvt_pk_bf16_f32 v243, v222, v223
    buffer_store_dword v243, v4, s[28:31], s61 offen offset:2048
    v_cvt_pk_bf16_f32 v244, v224, v225
    buffer_store_dword v244, v4, s[28:31], s62 offen offset:0
    v_cvt_pk_bf16_f32 v245, v226, v227
    buffer_store_dword v245, v4, s[28:31], s62 offen offset:2048
    v_cvt_pk_bf16_f32 v246, v228, v229
    buffer_store_dword v246, v4, s[28:31], s63 offen offset:0
    v_cvt_pk_bf16_f32 v247, v230, v231
    buffer_store_dword v247, v4, s[28:31], s63 offen offset:2048
L_epid:
    s_mov_b32 s41, 1
    s_cmp_lg_u32 s40, 0
    s_cbranch_scc1 L_fin
L_g3loop:
    s_sub_u32 s55, s55, 1
    s_cbranch_scc1 L_end
    buffer_load_dwordx4 v[104:107], v24, s[32:35], 0 offen sc1
    buffer_load_dwordx4 v[108:111], v24, s[32:35], s56 offen sc1
    buffer_load_dwordx4 v[112:115], v25, s[32:35], 0 offen sc1
    buffer_load_dwordx4 v[116:119], v25, s[32:35], s56 offen sc1
    s_waitcnt vmcnt(0)
    s_branch L_g3chk
L_g3bad:
    s_cmp_lg_u32 s41, 0
    s_cbranch_scc1 L_g3loop
    s_waitcnt vmcnt(0)
    s_branch L_y
L_owner:
    v_lshlrev_b32 v36, 16, v88
    v_and_b32 v38, s1, v88
    v_lshlrev_b32 v40, 16, v89
    v_and_b32 v42, s1, v89
    v_lshlrev_b32 v44, 16, v90
    v_and_b32 v46, s1, v90
    v_lshlrev_b32 v48, 16, v91
    v_and_b32 v50, s1, v91
    v_lshlrev_b32 v37, 16, v96
    v_and_b32 v39, s1, v96
    v_lshlrev_b32 v41, 16, v97
    v_and_b32 v43, s1, v97
    v_lshlrev_b32 v45, 16, v98
    v_and_b32 v47, s1, v98
    v_lshlrev_b32 v49, 16, v99
    v_and_b32_e64 v51, s1, v99
    v_pk_fma_f32 v[200:201], v[36:37], v[168:169], v[200:201]
    v_pk_fma_f32 v[202:203], v[38:39], v[170:171], v[202:203]
    v_pk_fma_f32 v[204:205], v[40:41], v[172:173], v[204:205]
    v_pk_fma_f32 v[206:207], v[42:43], v[174:175], v[206:207]
    v_pk_fma_f32 v[208:209], v[44:45], v[176:177], v[208:209]
    v_pk_fma_f32 v[210:211], v[46:47], v[178:179], v[210:211]
    v_pk_fma_f32 v[212:213], v[48:49], v[180:181], v[212:213]
    v_pk_fma_f32 v[214:215], v[50:51], v[182:183], v[214:215]
    v_lshlrev_b32 v36, 16, v92
    v_and_b32 v38, s1, v92
    v_lshlrev_b32 v40, 16, v93
    v_and_b32 v42, s1, v93
    v_lshlrev_b32 v44, 16, v94
    v_and_b32 v46, s1, v94
    v_lshlrev_b32 v48, 16, v95
    v_and_b32 v50, s1, v95
    v_lshlrev_b32 v37, 16, v100
    v_and_b32 v39, s1, v100
    v_lshlrev_b32 v41, 16, v101
    v_and_b32 v43, s1, v101
    v_lshlrev_b32 v45, 16, v102
    v_and_b32 v47, s1, v102
    v_lshlrev_b32 v49, 16, v103
    v_and_b32 v51, s1, v103
    v_pk_fma_f32 v[216:217], v[36:37], v[184:185], v[216:217]
    v_pk_fma_f32 v[218:219], v[38:39], v[186:187], v[218:219]
    v_pk_fma_f32 v[220:221], v[40:41], v[188:189], v[220:221]
    v_pk_fma_f32 v[222:223], v[42:43], v[190:191], v[222:223]
    v_pk_fma_f32 v[224:225], v[44:45], v[192:193], v[224:225]
    v_pk_fma_f32 v[226:227], v[46:47], v[194:195], v[226:227]
    v_pk_fma_f32 v[228:229], v[48:49], v[196:197], v[228:229]
    v_pk_fma_f32 v[230:231], v[50:51], v[198:199], v[230:231]
    s_mov_b32 s47, 0
    s_lshr_b32 s100, s96, 4
    s_cmp_lg_u32 s100, s54
    s_cbranch_scc1 L_own0
    s_and_b32 s100, s96, 15
    s_bitset1_b32 s47, s100
    s_lshl_b32 s100, s100, 1
    s_set_gpr_idx_on s100, gpr_idx(SRC0)
    s_nop 1
    v_mov_b32 v36, v200
    v_mov_b32 v38, v201
    s_set_gpr_idx_off
    v_mov_b32 v37, s51
    v_mov_b32 v39, s52
    s_lshl_b32 s100, s48, 11
    s_add_u32 s100, s100, 196608
    buffer_store_dwordx4 v[36:39], v8, s[32:35], s100 offen
L_own0:
    s_lshr_b32 s100, s97, 4
    s_cmp_lg_u32 s100, s54
    s_cbranch_scc1 L_own1
    s_and_b32 s100, s97, 15
    s_bitset1_b32 s47, s100
    s_lshl_b32 s100, s100, 1
    s_set_gpr_idx_on s100, gpr_idx(SRC0)
    s_nop 1
    v_mov_b32 v40, v200
    v_mov_b32 v42, v201
    s_set_gpr_idx_off
    v_mov_b32 v41, s51
    v_mov_b32 v43, s52
    s_lshl_b32 s100, s48, 11
    s_add_u32 s100, s100, 197632
    buffer_store_dwordx4 v[40:43], v8, s[32:35], s100 offen
L_own1:
    v_cvt_pk_bf16_f32 v232, v200, v201
    s_bitcmp1_b32 s47, 0
    s_cselect_b32 s100, 0x40000000, 0
    buffer_store_dword v232, v4, s[28:31], s100 offen offset:0
    v_cvt_pk_bf16_f32 v233, v202, v203
    s_bitcmp1_b32 s47, 1
    s_cselect_b32 s100, 0x40000000, 0
    buffer_store_dword v233, v4, s[28:31], s100 offen offset:2048
    v_cvt_pk_bf16_f32 v234, v204, v205
    s_bitcmp1_b32 s47, 2
    s_cselect_b32 s100, 0x40000000, s57
    buffer_store_dword v234, v4, s[28:31], s100 offen offset:0
    v_cvt_pk_bf16_f32 v235, v206, v207
    s_bitcmp1_b32 s47, 3
    s_cselect_b32 s100, 0x40000000, s57
    buffer_store_dword v235, v4, s[28:31], s100 offen offset:2048
    v_cvt_pk_bf16_f32 v236, v208, v209
    s_bitcmp1_b32 s47, 4
    s_cselect_b32 s100, 0x40000000, s58
    buffer_store_dword v236, v4, s[28:31], s100 offen offset:0
    v_cvt_pk_bf16_f32 v237, v210, v211
    s_bitcmp1_b32 s47, 5
    s_cselect_b32 s100, 0x40000000, s58
    buffer_store_dword v237, v4, s[28:31], s100 offen offset:2048
    v_cvt_pk_bf16_f32 v238, v212, v213
    s_bitcmp1_b32 s47, 6
    s_cselect_b32 s100, 0x40000000, s59
    buffer_store_dword v238, v4, s[28:31], s100 offen offset:0
    v_cvt_pk_bf16_f32 v239, v214, v215
    s_bitcmp1_b32 s47, 7
    s_cselect_b32 s100, 0x40000000, s59
    buffer_store_dword v239, v4, s[28:31], s100 offen offset:2048
    v_cvt_pk_bf16_f32 v240, v216, v217
    s_bitcmp1_b32 s47, 8
    s_cselect_b32 s100, 0x40000000, s60
    buffer_store_dword v240, v4, s[28:31], s100 offen offset:0
    v_cvt_pk_bf16_f32 v241, v218, v219
    s_bitcmp1_b32 s47, 9
    s_cselect_b32 s100, 0x40000000, s60
    buffer_store_dword v241, v4, s[28:31], s100 offen offset:2048
    v_cvt_pk_bf16_f32 v242, v220, v221
    s_bitcmp1_b32 s47, 10
    s_cselect_b32 s100, 0x40000000, s61
    buffer_store_dword v242, v4, s[28:31], s100 offen offset:0
    v_cvt_pk_bf16_f32 v243, v222, v223
    s_bitcmp1_b32 s47, 11
    s_cselect_b32 s100, 0x40000000, s61
    buffer_store_dword v243, v4, s[28:31], s100 offen offset:2048
    v_cvt_pk_bf16_f32 v244, v224, v225
    s_bitcmp1_b32 s47, 12
    s_cselect_b32 s100, 0x40000000, s62
    buffer_store_dword v244, v4, s[28:31], s100 offen offset:0
    v_cvt_pk_bf16_f32 v245, v226, v227
    s_bitcmp1_b32 s47, 13
    s_cselect_b32 s100, 0x40000000, s62
    buffer_store_dword v245, v4, s[28:31], s100 offen offset:2048
    v_cvt_pk_bf16_f32 v246, v228, v229
    s_bitcmp1_b32 s47, 14
    s_cselect_b32 s100, 0x40000000, s63
    buffer_store_dword v246, v4, s[28:31], s100 offen offset:0
    v_cvt_pk_bf16_f32 v247, v230, v231
    s_bitcmp1_b32 s47, 15
    s_cselect_b32 s100, 0x40000000, s63
    buffer_store_dword v247, v4, s[28:31], s100 offen offset:2048
    s_branch L_epid
L_fin:
    s_cmp_lg_u32 s50, 0
    s_cbranch_scc1 L_done
    v_bfe_u32 v22, v1, 1, 1
    v_and_b32 v23, 1, v1
    v_lshlrev_b32 v24, 10, v22
    v_lshl_add_u32 v24, v23, 4, v24
    s_lshl_b32 s100, s48, 11
    s_lshl_b32 s101, s49, 5
    s_add_u32 s100, s100, s101
    s_add_u32 s100, s100, 196608
    v_add_u32 v24, s100, v24
L_finre:
    buffer_load_dwordx4 v[168:171], v28, s[32:35], 0 offen offset:0 sc1
    buffer_load_dwordx4 v[172:175], v28, s[32:35], 0 offen offset:1024 sc1
    buffer_load_dwordx4 v[176:179], v28, s[32:35], 0 offen offset:2048 sc1
    buffer_load_dwordx4 v[180:183], v28, s[32:35], 0 offen offset:3072 sc1
    buffer_load_dwordx4 v[184:187], v28, s[32:35], s57 offen offset:0 sc1
    buffer_load_dwordx4 v[188:191], v28, s[32:35], s57 offen offset:1024 sc1
    buffer_load_dwordx4 v[192:195], v28, s[32:35], s57 offen offset:2048 sc1
    buffer_load_dwordx4 v[196:199], v28, s[32:35], s57 offen offset:3072 sc1
    buffer_load_dwordx4 v[136:139], v24, s[32:35], 0 offen sc1
    v_cmp_eq_u32 vcc, 1, v22
    v_mov_b32 v36, s98
    v_mov_b32 v37, s99
    v_cndmask_b32 v36, v36, v37, vcc
    v_not_b32_e64 v25, v36
    v_and_b32 v25, 0x7ff, v25
    v_lshlrev_b32_e64 v25, 11, v25
    v_lshl_add_u32 v25, v23, 2, v25
    v_ashrrev_i32 v37, 31, v36
    v_not_b32 v37, v37
    v_or_b32 v37, 0x80000000, v37
    v_xor_b32 v36, v36, v37
    v_and_b32 v36, s1, v36
    v_mul_f32 v36, 0xbfb8aa3b, v36
    v_exp_f32 v36, v36
    s_lshl_b32 s100, s48, 8
    s_lshl_b32 s101, s49, 3
    v_add_f32 v36, 1.0, v36
    v_rcp_f32 v36, v36
    s_add_u32 s56, s100, s101
    v_mov_b32 v38, 0
    s_waitcnt vmcnt(0)
    v_xor_b32 v169, s51, v169
    v_xor_b32 v171, s52, v171
    v_or3_b32 v38, v38, v169, v171
    v_xor_b32 v173, s51, v173
    v_xor_b32 v175, s52, v175
    v_or3_b32 v38, v38, v173, v175
    v_xor_b32 v177, s51, v177
    v_xor_b32 v179, s52, v179
    v_or3_b32 v38, v38, v177, v179
    v_xor_b32 v181, s51, v181
    v_xor_b32 v183, s52, v183
    v_or3_b32 v38, v38, v181, v183
    v_xor_b32 v185, s51, v185
    v_xor_b32 v187, s52, v187
    v_or3_b32 v38, v38, v185, v187
    v_xor_b32 v189, s51, v189
    v_xor_b32 v191, s52, v191
    v_or3_b32 v38, v38, v189, v191
    v_xor_b32 v193, s51, v193
    v_xor_b32 v195, s52, v195
    v_or3_b32 v38, v38, v193, v195
    v_xor_b32 v197, s51, v197
    v_xor_b32 v199, s52, v199
    v_or3_b32 v38, v38, v197, v199
    v_xor_b32 v137, s51, v137
    v_xor_b32 v139, s52, v139
    v_or3_b32 v38, v38, v137, v139
    v_cmp_ne_u32 vcc, 0, v38
    s_nop 0
    s_cmp_eq_u64 vcc, 0
    s_cbranch_scc1 L_finok
    s_sub_u32 s55, s55, 1
    s_cbranch_scc1 L_end
    s_branch L_finre
L_finok:
    v_add_f32 v168, v168, v184
    v_add_f32 v170, v170, v186
    v_add_f32 v172, v172, v188
    v_add_f32 v174, v174, v190
    v_add_f32 v176, v176, v192
    v_add_f32 v178, v178, v194
    v_add_f32 v180, v180, v196
    v_add_f32 v182, v182, v198
    v_add_f32 v168, v168, v176
    v_add_f32 v170, v170, v178
    v_add_f32 v172, v172, v180
    v_add_f32 v174, v174, v182
    v_add_f32 v168, v168, v172
    v_add_f32 v170, v170, v174
    s_nop 0
    v_add_f32_dpp v168, v168, v168 row_ror:4 row_mask:0xf bank_mask:0xf
    v_add_f32_dpp v170, v170, v170 row_ror:4 row_mask:0xf bank_mask:0xf
    s_nop 0
    v_add_f32_dpp v168, v168, v168 row_ror:8 row_mask:0xf bank_mask:0xf
    v_add_f32_dpp v170, v170, v170 row_ror:8 row_mask:0xf bank_mask:0xf
    v_mov_b32 v169, v168
    v_mov_b32 v171, v170
    s_nop 0
    v_permlane16_swap_b32 v168, v169
    v_permlane16_swap_b32 v170, v171
    v_add_f32 v168, v168, v169
    v_add_f32 v170, v170, v171
    v_mov_b32 v169, v168
    v_mov_b32 v171, v170
    s_nop 0
    v_permlane32_swap_b32 v168, v169
    v_permlane32_swap_b32 v170, v171
    v_add_f32 v168, v168, v169
    v_add_f32_e64 v170, v170, v171
    v_fma_f32 v168, v168, v36, v136
    v_fma_f32 v170, v170, v36, v138
    v_cvt_pk_bf16_f32 v168, v168, v170
    s_mov_b64 exec, 15
    buffer_store_dword v168, v25, s[28:31], s56 offen
    s_mov_b64 exec, -1
L_done:
L_end:
    s_endpgm
L_pollbad:
    buffer_load_dword v253, v11, s[32:35], s53 offen sc1
    s_sub_u32 s55, s55, 1
    s_cbranch_scc1 L_end
    s_add_u32 s95, s95, 1
    s_cmp_lt_u32 s95, 8
    s_cbranch_scc1 L_pollw
    s_cmp_lg_u32 s90, 0
    s_cbranch_scc1 L_pollw
    v_mov_b32 v22, 56960
    s_cmp_lg_u32 s50, 0
    s_cbranch_scc1 L_rolerd
    s_mov_b32 s97, s49
L_claimloop:
    s_waitcnt lgkmcnt(0)
    s_bitcmp0_b32 s88, s97
    s_cbranch_scc1 L_claimed
    s_ff0_i32_b32 s97, s88
    s_cmp_lt_i32 s97, 0
    s_cbranch_scc1 L_pollw
    s_lshl_b32 s88, 1, s97
    s_atomic_or s88, s[36:37], s92 glc
    s_branch L_claimloop
L_claimed:
    v_mov_b32 v23, s97
    ds_write_b32 v22, v23
L_rolerd:
    ds_read_b32 v23, v22
    s_waitcnt lgkmcnt(0)
    v_readfirstlane_b32 s97, v23
    s_nop 0
    s_and_b32 s97, s97, 31
    s_cmp_eq_u32 s97, s49
    s_cbranch_scc1 L_pollw
    s_mov_b32 s49, s97
    s_mov_b32 s90, 1
    s_waitcnt vmcnt(0)
    s_branch L_restart
L_nonce_re:
    s_sub_u32 s55, s55, 1
    s_cbranch_scc1 L_end
    buffer_load_dword v255, v7, s[36:39], 0 offen sc1
    s_waitcnt vmcnt(0)
    s_branch L_nonce_chk
L_g1_re:
    s_sub_u32 s55, s55, 1
    s_cbranch_scc1 L_end
    buffer_load_dwordx4 v[56:59], v7, s[32:35], 0 offen sc1
    buffer_load_dwordx4 v[60:63], v7, s[32:35], s57 offen sc1
    s_waitcnt vmcnt(0)
    s_branch L_g1_chk
L_xs_re:
    s_sub_u32 s55, s55, 1
    s_cbranch_scc1 L_end
    buffer_load_dwordx2 v[32:33], v13, s[32:35], 0 offen sc1
    s_waitcnt vmcnt(0)
    s_branch L_xs_chk
L_g2_re:
    s_sub_u32 s55, s55, 1
    s_cbranch_scc1 L_end
    buffer_load_dwordx2 v[248:249], v251, s[32:35], 0 offen sc1
    s_waitcnt vmcnt(0)
    s_branch L_g2_chk
L_poll1_re:
    s_sub_u32 s55, s55, 1
    s_cbranch_scc1 L_end
    buffer_load_dword v254, v11, s[32:35], s53 offen offset:128 sc1
    s_waitcnt vmcnt(0)
    s_branch L_poll1_chk
L_y_re:
    s_sub_u32 s55, s55, 1
    s_cbranch_scc1 L_end
    buffer_load_dwordx4 v[88:91], v29, s[28:31], 0 offen offset:0 sc1
    buffer_load_dwordx4 v[96:99], v29, s[28:31], s60 offen offset:0 sc1
    buffer_load_dwordx4 v[92:95], v29, s[28:31], 0 offen offset:16 sc1
    buffer_load_dwordx4 v[100:103], v29, s[28:31], s60 offen offset:16 sc1
    s_waitcnt vmcnt(0)
    s_branch L_y_chk
.p2align 8
.fill (20480 - (. - parallel_sum__ssm_conv_h3__moe_arch_mod__prompt_kernel))/4, 4, 0xbf810000
.section .rodata,"a"
.p2align 6
.amdhsa_kernel parallel_sum__ssm_conv_h3__moe_arch_mod__prompt_kernel
  .amdhsa_next_free_vgpr 512
  .amdhsa_next_free_sgpr 102
  .amdhsa_accum_offset 256
  .amdhsa_group_segment_fixed_size 0
  .amdhsa_kernarg_size 112
  .amdhsa_user_sgpr_count 2
  .amdhsa_user_sgpr_kernarg_segment_ptr 1
  .amdhsa_system_sgpr_workgroup_id_x 1
  .amdhsa_float_denorm_mode_32 3
.end_amdhsa_kernel
```
